```python
import torch

def _softmax(x, axis=-1):
    return torch.softmax(x, dim=axis)
def _gelu(x):
    return torch.nn.functional.gelu(x, approximate="tanh")
def _silu(x):
    return torch.nn.functional.silu(x)
def _sigmoid(x):
    return torch.sigmoid(x)
def _layernorm(x, axis=-1, eps=1e-5):
    m = x.mean(dim=axis, keepdim=True)
    v = x.var(dim=axis, keepdim=True, unbiased=False)
    return (x - m) / torch.sqrt(v + eps)
def _scatter_add(tgt, idx, src, axis=0):
    return tgt.clone().index_add_(axis, idx, src)
def _segment_sum(src, seg, n):
    out = torch.zeros((n,) + src.shape[1:], dtype=src.dtype)
    return out.index_add_(0, seg, src)
def _pad(x, pw):
    flat = tuple(v for pair in reversed(pw) for v in pair)
    return torch.nn.functional.pad(x, flat)

kernel_name = 'parallel_sum__sliding_block__moe_arch_mod__prompt'

def setup_inputs():

    _w = (lambda a: (lambda t: t.to(torch.bfloat16) if t.is_floating_point() else t)(torch.as_tensor(a)))
    def _A_setup():
        B, S, D = 1, 2048, 512
        return {
            "x": _w((lambda *s: torch.randn(*s, dtype=torch.bfloat16) * 0.05)(B, S, D)),
            "wqkv": _w((lambda *s: torch.randn(*s, dtype=torch.bfloat16) * 0.05)(D, 3 * D)),
            "wo": _w((lambda *s: torch.randn(*s, dtype=torch.bfloat16) * 0.05)(D, D)),
        }
    _A_in = _A_setup()

    def _B_setup():
        B, S, D, F, C = 1, 2048, 512, 1376, 1
        return {
            "x": _w((lambda *s: torch.randn(*s, dtype=torch.bfloat16) * 0.05)(B, S, D)),
            "w_r": _w((lambda *s: torch.randn(*s, dtype=torch.bfloat16) * 0.05)(D)),
            "w_gate": _w((lambda *s: torch.randn(*s, dtype=torch.bfloat16) * 0.05)(D, F)),
            "w_up": _w((lambda *s: torch.randn(*s, dtype=torch.bfloat16) * 0.05)(D, F)),
            "w_down": _w((lambda *s: torch.randn(*s, dtype=torch.bfloat16) * 0.05)(F, D)),
        }
    _B_in = _B_setup()

    return {
        "A_x": _A_in["x"],
        "A_wqkv": _A_in["wqkv"],
        "A_wo": _A_in["wo"],
        "B_x": _B_in["x"],
        "B_w_r": _B_in["w_r"],
        "B_w_gate": _B_in["w_gate"],
        "B_w_up": _B_in["w_up"],
        "B_w_down": _B_in["w_down"],
    }

def reference(A_x, A_wqkv, A_wo, B_x, B_w_r, B_w_gate, B_w_up, B_w_down):
    def _A_ref(x, wqkv, wo):
        B, S, D = x.shape
        H = 32; Dh = D // H; W = 256
        qkv = (lambda x, *d: x.permute(*d))((x @ wqkv).reshape(B, S, 3, H, Dh), 2, 0, 3, 1, 4)
        q, k, v = qkv[0], qkv[1], qkv[2]
        scores = torch.einsum("bhqd,bhkd->bhqk", q, k) * (Dh ** -0.5)
        idx = torch.arange(S)
        mask = (idx[:, None] - idx[None, :] >= 0) & (idx[:, None] - idx[None, :] < W)
        scores = torch.where(mask[None, None], scores, -1e9)
        p = _softmax(scores, axis=-1)
        o = torch.einsum("bhqk,bhkd->bhqd", p, v)
        return (lambda x, *d: x.permute(*d))(o, 0, 2, 1, 3).reshape(B, S, D) @ wo

    def _B_ref(x, w_r, w_gate, w_up, w_down):
        B, S, D = x.shape
        C = 1
        r = x @ w_r
        idx = torch.argsort(-r, axis=-1)[:, :C]
        idx_e = (lambda x, n, axis: torch.repeat_interleave(x, n, dim=axis))(idx.reshape(B, C, 1), D, axis=2)
        x_sel = (lambda x, i, axis: torch.take_along_dim(x, i, dim=axis))(x, idx_e, axis=1)
        g = _silu(x_sel @ w_gate)
        u = x_sel @ w_up
        y = (g * u) @ w_down
        r_sel = _sigmoid((lambda x, i, axis: torch.take_along_dim(x, i, dim=axis))(r, idx, axis=1))
        y = y * r_sel.reshape(B, C, 1)
        b_off = (torch.arange(B) * S).reshape(B, 1)
        flat_idx = (idx + b_off).reshape(B * C)
        zero = (x * 0.0).reshape(B * S, D)
        upd = _scatter_add(zero, flat_idx, y.reshape(B * C, D), axis=0)
        return x + upd.reshape(B, S, D)

    x = A_x
    xn = _layernorm(x, axis=-1)
    return x + _A_ref(xn, A_wqkv, A_wo) + _B_ref(xn, B_w_r, B_w_gate, B_w_up, B_w_down)
```

```asm
; @launch grid=(256,1,1) block=(512,1,1) lds=163840
.amdgcn_target "amdgcn-amd-amdhsa--gfx950"
.text
.globl parallel_sum__sliding_block__moe_arch_mod__prompt_kernel
.p2align 8
.type parallel_sum__sliding_block__moe_arch_mod__prompt_kernel,@function
parallel_sum__sliding_block__moe_arch_mod__prompt_kernel:
    s_load_dwordx2 s[8:9], s[0:1], 0
    s_load_dwordx2 s[12:13], s[0:1], 8
    s_load_dwordx2 s[20:21], s[0:1], 72
    s_load_dwordx2 s[24:25], s[0:1], 32
    s_memrealtime s[92:93]
    s_getpc_b64 s[94:95]
L_pc:
    s_cmp_ge_u32 s2, 256
    s_cbranch_scc1 L_exit
    s_and_b32 s3, s2, 0xf8
    v_lshrrev_b32 v232, 6, v0
    v_add_lshl_u32 v233, v232, s3, 7
    v_readfirstlane_b32 s62, v232
    v_min_u32 v233, L_code_end - L_pc - 4, v233
    v_and_b32 v1, 63, v0
    global_load_dword v17, v233, s[94:95]
    s_lshr_b32 s3, s2, 5
    s_bfe_u32 s4, s2, 0x20003
    s_bfe_u32 s5, s2, 0x20001
    s_lshl3_add_u32 s60, s5, s3
    s_and_b32 s5, s2, 1
    s_lshl2_add_u32 s61, s5, s4
    s_add_u32 s64, s4, s3
    s_and_b32 s64, s64, 3
    s_lshl_b32 s64, s64, 7
    v_lshrrev_b32 v232, 3, v0
    v_bfe_u32 v234, v0, 4, 3
    v_and_b32 v233, 7, v0
    v_xor_b32 v235, v234, v233
    v_lshlrev_b32 v235, 4, v235
    v_lshl_add_u32 v8, v232, 10, v235
    s_lshl_b32 s3, s60, 16
    v_add_u32 v8, s3, v8
    s_mov_b32 s10, 2097152
    s_mov_b32 s11, 0x00020000
    s_lshl_b32 s63, s62, 10
    v_and_b32 v235, 16, v0
    v_lshlrev_b32 v234, 4, v233
    v_lshlrev_b32 v235, 2, v235
    v_xor_b32 v235, v235, v234
    v_mul_u32_u24 v9, 3072, v232
    s_lshl_b32 s4, s61, 7
    s_add_u32 s4, s4, 1024
    v_add3_u32 v9, v9, v235, s4
    s_mov_b32 s14, 1572864
    s_mov_b32 s15, 0x00020000
    s_mul_i32 s52, s64, 1536
    s_add_u32 m0, s63, 65536
    s_waitcnt lgkmcnt(0)
    buffer_load_dwordx4 v8, s[8:11], s64 offen  lds
    s_add_u32 m0, s63, 0
    s_nop 0
    buffer_load_dwordx4 v9, s[12:15], s52 offen  lds
    s_xor_b32 s82, s64, 128
    s_add_u32 m0, s63, 73728
    s_mul_i32 s53, s82, 1536
    buffer_load_dwordx4 v8, s[8:11], s82 offen  lds
    s_add_u32 m0, s63, 8192
    s_nop 0
    buffer_load_dwordx4 v9, s[12:15], s53 offen  lds
    v_lshlrev_b32 v2, 4, v1
    v_mov_b32 v3, 0
    s_mov_b32 s22, 256
    s_mov_b32 s23, 0x00020000
    s_cmp_lg_u32 s62, 4
    s_cbranch_scc1 L_notw0
    s_mov_b32 s26, 1024
    s_mov_b32 s27, 0x00020000
    s_mov_b32 m0, 155648
    v_xor_b32 v235, s64, v2
    buffer_load_dwordx4 v235, s[24:27], 0 offen lds
    s_lshl_b32 s5, s2, 8
    s_or_b32 s6, s92, 1
    v_mov_b32 v235, s6
    buffer_store_dword v235, v3, s[20:23], s5 offen sc1
L_notw0:
    s_cmp_lt_u32 s62, 4
    s_cbranch_scc1 L_not1
    s_cmp_lg_u32 s62, 5
    s_cbranch_scc1 L_t1_0
    s_lshl3_add_u32 s83, s60, s61
    s_lshl_b32 s83, s83, 13
    v_or_b32 v255, 4, v1
    v_lshlrev_b32 v255, 7, v255
    buffer_load_dword v255, v255, s[8:11], s83 offen
    s_branch L_t1_done
L_t1_0:
    s_cmp_lg_u32 s62, 4
    s_cbranch_scc1 L_t1_1
    s_mul_i32 s83, s60, 192
    s_add_u32 s83, s83, s61
    s_lshl_b32 s83, s83, 7
    s_add_u32 s83, s83, 787456
    v_and_b32 v255, 7, v1
    v_mul_u32_u24 v255, 3072, v255
    buffer_load_dword v255, v255, s[12:15], s83 offen
    s_branch L_t1_done
L_t1_1:
    s_cmp_lg_u32 s62, 6
    s_cbranch_scc1 L_t1_2
    s_mul_i32 s83, s60, 384
    s_add_u32 s83, s83, s61
    s_lshl_b32 s83, s83, 7
    s_add_u32 s83, s83, 2048
    v_and_b32 v255, 15, v1
    v_mul_u32_u24 v255, 3072, v255
    buffer_load_dword v255, v255, s[12:15], s83 offen
    s_branch L_t1_done
L_t1_2:
    s_cmp_lg_u32 s62, 7
    s_cbranch_scc1 L_t1_3
    s_mul_i32 s83, s60, 384
    s_add_u32 s83, s83, s61
    s_lshl_b32 s83, s83, 7
    s_add_u32 s83, s83, 0
    v_and_b32 v255, 15, v1
    v_mul_u32_u24 v255, 3072, v255
    buffer_load_dword v255, v255, s[12:15], s83 offen
L_t1_3:
L_t1_done:
L_not1:
    s_load_dwordx2 s[16:17], s[0:1], 80
    s_load_dwordx2 s[28:29], s[0:1], 16
    s_load_dwordx2 s[32:33], s[0:1], 40
    s_load_dwordx2 s[36:37], s[0:1], 48
    s_load_dwordx2 s[40:41], s[0:1], 56
    s_load_dwordx2 s[44:45], s[0:1], 64
    s_mov_b32 s90, 0x3f803f80
    s_mov_b32 s91, 0x3f803f80
    s_mov_b32 s76, 0xffff0000
    s_lshr_b32 s68, s62, 2
    s_and_b32 s70, s62, 3
    s_lshl_b32 s71, s70, 10
    s_and_b32 s85, s62, 1
    s_lshr_b32 s84, s70, 1
    s_xor_b32 s4, s85, s84
    v_and_b32 v232, 31, v1
    s_lshl_b32 s5, s84, 5
    v_add_u32 v0, s5, v232
    v_lshrrev_b32 v233, 5, v1
    s_lshl_b32 s5, s4, 1
    v_add_u32 v234, s5, v233
    v_bfe_u32 v235, v0, 1, 3
    v_xor_b32 v235, v235, v234
    v_lshlrev_b32 v235, 4, v235
    v_lshl_add_u32 v10, v0, 7, v235
    v_add_u32 v10, 65536, v10
    v_xor_b32 v11, 32, v10
    v_xor_b32 v12, 64, v10
    v_xor_b32 v13, 96, v10
    v_lshlrev_b32 v234, 4, v234
    v_add_u32 v16, 155648, v234
    v_mov_b64 v[28:29], 0
    s_mov_b32 exec_lo, 0x22221111
    s_mov_b32 exec_hi, 0x22221111
    v_mov_b64 v[28:29], s[90:91]
    s_mov_b64 exec, -1
    v_mov_b64 v[30:31], v[28:29]
    v_bfe_u32 v234, v1, 2, 2
    v_lshl_add_u32 v234, v233, 3, v234
    v_and_b32 v235, 8, v1
    v_lshlrev_b32 v235, 3, v235
    s_lshl_b32 s5, s85, 6
    v_xor_b32 v235, s5, v235
    v_lshl_add_u32 v234, v234, 7, v235
    v_and_b32 v235, 16, v1
    v_lshl_add_u32 v234, v235, 1, v234
    v_and_b32 v235, 3, v1
    v_lshl_add_u32 v234, v235, 3, v234
    s_lshl_b32 s5, s4, 11
    v_add_u32 v14, s5, v234
    v_xor_b32 v15, 2048, v14
    s_mov_b32 s18, 268435456
    s_mov_b32 s19, 0x00020000
    s_mov_b32 s30, 524288
    s_mov_b32 s31, 0x00020000
    s_mov_b32 s34, 1409024
    s_mov_b32 s35, 0x00020000
    s_mov_b32 s38, 1409024
    s_mov_b32 s39, 0x00020000
    s_mov_b32 s42, 1409024
    s_mov_b32 s43, 0x00020000
    s_mov_b32 s46, 2097152
    s_mov_b32 s47, 0x00020000
    v_lshrrev_b32 v233, 5, v1
    v_and_b32 v235, 15, v1
    s_lshl_b32 s6, s85, 8
    s_add_u32 s6, s6, 160768
    s_lshl2_add_u32 s5, s84, s6
    v_lshl_add_u32 v19, v235, 3, s5
    v_and_b32 v234, 31, v1
    v_lshl_add_u32 v253, v234, 3, s6
    s_lshl3_add_u32 s7, s60, s61
    s_lshl_b32 s3, s7, 13
    s_add_u32 s66, s3, s63
    s_lshl1_add_u32 s81, s71, s3
    s_min_u32 s67, s60, 4
    s_and_b32 s4, s60, 7
    s_cmp_eq_u32 s4, s61
    s_cselect_b32 s96, 0x88884444, 0
    s_mov_b32 s97, s96
    s_lshl_b32 s7, s7, 9
    s_add_u32 s7, s7, 6291456
    v_lshrrev_b32 v234, 4, v1
    v_lshl_add_u32 v4, v234, 2, s7
    s_sub_u32 s48, s66, 65536
    s_cselect_b32 s48, 1073741824, s48
    s_sub_u32 s49, s66, 131072
    s_cselect_b32 s49, 1073741824, s49
    s_sub_u32 s50, s66, 196608
    s_cselect_b32 s50, 1073741824, s50
    s_sub_u32 s51, s66, 262144
    s_cselect_b32 s51, 1073741824, s51
    s_lshl4_add_u32 s5, s62, s7
    s_sub_u32 s5, s5, 4096
    v_lshl_add_u32 v244, v234, 2, s5
    v_lshlrev_b32 v232, 12, v235
    v_sub_u32 v244, v244, v232
    v_cmp_le_u32 vcc, s67, v235
    v_add_u32 v246, 2097152, v2
    s_mov_b64 exec, vcc
    v_mov_b32 v244, 1073741824
    s_mov_b64 exec, -1
    v_and_b32 v232, 31, v1
    v_lshrrev_b32 v233, 5, v1
    v_lshlrev_b32 v233, 2, v233
    v_sub_u32 v232, v233, v232
    v_add_u32 v233, -1, v232
    v_add_u32 v234, 0, v232
    v_lshrrev_b32 v233, 16, v233
    v_and_or_b32 v224, v234, s76, v233
    v_add_u32 v233, 1, v232
    v_add_u32 v234, 2, v232
    v_lshrrev_b32 v233, 16, v233
    v_and_or_b32 v225, v234, s76, v233
    v_add_u32 v233, 7, v232
    v_add_u32 v234, 8, v232
    v_lshrrev_b32 v233, 16, v233
    v_and_or_b32 v226, v234, s76, v233
    v_add_u32 v233, 9, v232
    v_add_u32 v234, 10, v232
    v_lshrrev_b32 v233, 16, v233
    v_and_or_b32 v227, v234, s76, v233
    v_add_u32 v233, 15, v232
    v_add_u32 v234, 16, v232
    v_lshrrev_b32 v233, 16, v233
    v_and_or_b32 v228, v234, s76, v233
    v_add_u32 v233, 17, v232
    v_add_u32 v234, 18, v232
    v_lshrrev_b32 v233, 16, v233
    v_and_or_b32 v229, v234, s76, v233
    v_add_u32 v233, 23, v232
    v_add_u32 v234, 24, v232
    v_lshrrev_b32 v233, 16, v233
    v_and_or_b32 v230, v234, s76, v233
    v_add_u32 v233, 25, v232
    v_add_u32 v234, 26, v232
    v_lshrrev_b32 v233, 16, v233
    v_and_or_b32 v231, v234, s76, v233
    v_lshrrev_b32 v233, 3, v1
    v_and_b32 v234, 0x70, v2
    v_lshl_add_u32 v247, v233, 10, v234
    s_lshl_b32 s3, s61, 7
    s_lshl3_add_u32 s78, s63, s3
    s_lshl_b32 s4, s60, 16
    s_add_u32 s77, s78, s4
    s_lshr_b32 s74, s2, 3
    v_lshrrev_b32 v232, 4, v1
    v_and_b32 v234, 0xf0, v2
    v_lshl_add_u32 v248, v232, 9, v234
    s_lshl_b32 s4, s85, 8
    s_lshl_b32 s6, s68, 12
    s_add_u32 s4, s4, s6
    s_lshl1_add_u32 s6, s60, s84
    s_lshl_b32 s7, s6, 15
    s_add_u32 s4, s4, s7
    s_add_u32 s4, s4, 4194304
    v_add_u32 v248, s4, v248
    s_lshl_b32 s6, s6, 11
    s_lshl_b32 s5, s68, 7
    s_add_u32 s6, s6, s5
    s_lshl2_add_u32 s6, s85, s6
    s_add_u32 s6, s6, 6291712
    v_mov_b32 v249, 1073741824
    v_and_b32 v235, 1, v1
    v_bfe_u32 v234, v1, 2, 2
    s_mov_b32 exec_lo, 0x33333333
    s_mov_b32 exec_hi, 0x33333333
    v_lshl_add_u32 v249, v232, 3, s6
    v_lshl_add_u32 v249, v235, 5, v249
    v_lshl_add_u32 v249, v234, 9, v249
    s_mov_b64 exec, -1
    v_bfe_u32 v234, v1, 2, 3
    v_lshrrev_b32 v235, 5, v1
    v_lshl_add_u32 v235, v235, 4, v234
    v_lshrrev_b32 v234, 1, v234
    v_lshlrev_b32 v234, 5, v234
    v_lshl_add_u32 v234, v235, 7, v234
    v_and_b32 v235, 3, v1
    v_lshl_add_u32 v250, v235, 3, v234
    v_and_b32 v232, 15, v1
    v_lshrrev_b32 v233, 4, v1
    v_and_b32 v234, 7, v1
    v_xor_b32 v233, v233, v234
    v_lshlrev_b32 v233, 4, v233
    v_lshl_add_u32 v232, v232, 8, v233
    s_lshl1_add_u32 s3, s84, s68
    s_lshl1_add_u32 s3, s3, s85
    s_lshl_b32 s3, s3, 12
    s_add_u32 s3, s3, 98304
    v_add_u32 v251, s3, v232
    v_lshrrev_b32 v232, 3, v1
    v_lshlrev_b32 v233, 1, v234
    v_xor_b32 v233, v233, v232
    v_lshlrev_b32 v233, 4, v233
    v_lshl_add_u32 v232, v232, 8, v233
    s_lshl1_add_u32 s4, s63, 98304
    v_add_u32 v252, s4, v232
    s_xor_b32 s82, s64, 256
    s_add_u32 m0, s63, 81920
    s_mul_i32 s54, s82, 1536
    buffer_load_dwordx4 v8, s[8:11], s82 offen  lds
    s_add_u32 m0, s63, 16384
    s_nop 0
    buffer_load_dwordx4 v9, s[12:15], s54 offen  lds
    s_xor_b32 s82, s64, 384
    s_add_u32 m0, s63, 90112
    s_mul_i32 s55, s82, 1536
    buffer_load_dwordx4 v8, s[8:11], s82 offen  lds
    s_add_u32 m0, s63, 24576
    s_nop 0
    buffer_load_dwordx4 v9, s[12:15], s55 offen  lds
    s_cmp_lg_u32 s68, 0
    s_cbranch_scc1 L_g1
    s_and_b32 s86, s2, 7
    s_lshl2_add_u32 s3, s86, s70
    s_mul_i32 s3, s3, 44032
    s_lshl_b32 s4, s74, 7
    s_add_u32 s3, s3, s4
    v_lshrrev_b32 v232, 3, v1
    v_mul_u32_u24 v232, 2752, v232
    v_bfe_u32 v234, v1, 4, 2
    v_lshlrev_b32 v234, 5, v234
    v_and_b32 v233, 0x70, v2
    v_xad_u32 v16, v233, v234, v232
    s_cmp_ge_u32 s74, 22
    s_cselect_b32 s88, 1073741824, s3
    s_add_u32 s89, s88, 22016
    s_waitcnt vmcnt(4) lgkmcnt(0)
    s_barrier
    ds_read_b64_tr_b16 v[176:177], v14 offset:0
    ds_read_b64_tr_b16 v[178:179], v14 offset:512
    ds_read_b64_tr_b16 v[180:181], v15 offset:0
    ds_read_b64_tr_b16 v[182:183], v15 offset:512
    ds_read_b64_tr_b16 v[184:185], v14 offset:4096
    ds_read_b64_tr_b16 v[186:187], v14 offset:4608
    ds_read_b64_tr_b16 v[188:189], v15 offset:4096
    ds_read_b64_tr_b16 v[190:191], v15 offset:4608
    ds_read_b128 v[32:35], v10 offset:0
    ds_read_b128 v[36:39], v11 offset:0
    ds_read_b128 v[40:43], v12 offset:0
    ds_read_b128 v[44:47], v13 offset:0
    buffer_load_dword v17, v3, s[20:23], 0 offen sc1
    s_barrier
    s_waitcnt lgkmcnt(0)
    v_mfma_f32_32x32x16_bf16 v[160:175], v[176:179], v[32:35], 0
    ds_read_b64_tr_b16 v[192:193], v14 offset:8192
    ds_read_b64_tr_b16 v[194:195], v14 offset:8704
    ds_read_b64_tr_b16 v[196:197], v15 offset:8192
    ds_read_b64_tr_b16 v[198:199], v15 offset:8704
    v_mfma_f32_32x32x16_bf16 v[160:175], v[180:183], v[36:39], v[160:175]
    ds_read_b64_tr_b16 v[200:201], v14 offset:12288
    ds_read_b64_tr_b16 v[202:203], v14 offset:12800
    ds_read_b64_tr_b16 v[204:205], v15 offset:12288
    ds_read_b64_tr_b16 v[206:207], v15 offset:12800
    v_mfma_f32_32x32x16_bf16 v[160:175], v[184:187], v[40:43], v[160:175]
    ds_read_b128 v[48:51], v10 offset:8192
    ds_read_b128 v[52:55], v11 offset:8192
    ds_read_b128 v[56:59], v12 offset:8192
    ds_read_b128 v[60:63], v13 offset:8192
    v_mfma_f32_32x32x16_bf16 v[160:175], v[188:191], v[44:47], v[160:175]
    v_mfma_f32_16x16x32_bf16 v[20:23], v[28:31], v[176:179], 0
    v_mfma_f32_16x16x32_bf16 v[20:23], v[28:31], v[184:187], v[20:23]
    s_xor_b32 s82, s64, 512
    s_add_u32 m0, s63, 98304
    s_mul_i32 s56, s82, 1536
    buffer_load_dwordx4 v8, s[8:11], s82 offen  lds
    s_add_u32 m0, s63, 32768
    s_nop 0
    buffer_load_dwordx4 v9, s[12:15], s56 offen  lds
    s_waitcnt vmcnt(5)
    s_barrier
    s_waitcnt lgkmcnt(0)
    v_mfma_f32_32x32x16_bf16 v[160:175], v[192:195], v[48:51], v[160:175]
    ds_read_b64_tr_b16 v[176:177], v14 offset:16384
    ds_read_b64_tr_b16 v[178:179], v14 offset:16896
    ds_read_b64_tr_b16 v[180:181], v15 offset:16384
    ds_read_b64_tr_b16 v[182:183], v15 offset:16896
    v_mfma_f32_32x32x16_bf16 v[160:175], v[196:199], v[52:55], v[160:175]
    ds_read_b64_tr_b16 v[184:185], v14 offset:20480
    ds_read_b64_tr_b16 v[186:187], v14 offset:20992
    ds_read_b64_tr_b16 v[188:189], v15 offset:20480
    ds_read_b64_tr_b16 v[190:191], v15 offset:20992
    v_mfma_f32_32x32x16_bf16 v[160:175], v[200:203], v[56:59], v[160:175]
    ds_read_b128 v[64:67], v10 offset:16384
    ds_read_b128 v[68:71], v11 offset:16384
    ds_read_b128 v[72:75], v12 offset:16384
    ds_read_b128 v[76:79], v13 offset:16384
    v_mfma_f32_32x32x16_bf16 v[160:175], v[204:207], v[60:63], v[160:175]
    v_mfma_f32_16x16x32_bf16 v[20:23], v[28:31], v[192:195], v[20:23]
    v_mfma_f32_16x16x32_bf16 v[20:23], v[28:31], v[200:203], v[20:23]
    s_xor_b32 s82, s64, 640
    s_add_u32 m0, s63, 106496
    s_mul_i32 s57, s82, 1536
    buffer_load_dwordx4 v8, s[8:11], s82 offen  lds
    s_add_u32 m0, s63, 40960
    s_nop 0
    buffer_load_dwordx4 v9, s[12:15], s57 offen  lds
    s_waitcnt vmcnt(5)
    s_barrier
    s_waitcnt lgkmcnt(0)
    v_mfma_f32_32x32x16_bf16 v[160:175], v[176:179], v[64:67], v[160:175]
    ds_read_b64_tr_b16 v[192:193], v14 offset:24576
    ds_read_b64_tr_b16 v[194:195], v14 offset:25088
    ds_read_b64_tr_b16 v[196:197], v15 offset:24576
    ds_read_b64_tr_b16 v[198:199], v15 offset:25088
    v_mfma_f32_32x32x16_bf16 v[160:175], v[180:183], v[68:71], v[160:175]
    ds_read_b64_tr_b16 v[200:201], v14 offset:28672
    ds_read_b64_tr_b16 v[202:203], v14 offset:29184
    ds_read_b64_tr_b16 v[204:205], v15 offset:28672
    ds_read_b64_tr_b16 v[206:207], v15 offset:29184
    v_mfma_f32_32x32x16_bf16 v[160:175], v[184:187], v[72:75], v[160:175]
    ds_read_b128 v[80:83], v10 offset:24576
    ds_read_b128 v[84:87], v11 offset:24576
    ds_read_b128 v[88:91], v12 offset:24576
    ds_read_b128 v[92:95], v13 offset:24576
    v_mfma_f32_32x32x16_bf16 v[160:175], v[188:191], v[76:79], v[160:175]
    v_mfma_f32_16x16x32_bf16 v[20:23], v[28:31], v[176:179], v[20:23]
    v_mfma_f32_16x16x32_bf16 v[20:23], v[28:31], v[184:187], v[20:23]
    s_xor_b32 s82, s64, 768
    s_add_u32 m0, s63, 114688
    s_mul_i32 s58, s82, 1536
    buffer_load_dwordx4 v8, s[8:11], s82 offen  lds
    s_add_u32 m0, s63, 49152
    s_nop 0
    buffer_load_dwordx4 v9, s[12:15], s58 offen  lds
    s_waitcnt vmcnt(4)
    s_barrier
    s_waitcnt lgkmcnt(0)
    v_mfma_f32_32x32x16_bf16 v[160:175], v[192:195], v[80:83], v[160:175]
    ds_read_b64_tr_b16 v[176:177], v14 offset:32768
    ds_read_b64_tr_b16 v[178:179], v14 offset:33280
    ds_read_b64_tr_b16 v[180:181], v15 offset:32768
    ds_read_b64_tr_b16 v[182:183], v15 offset:33280
    v_mfma_f32_32x32x16_bf16 v[160:175], v[196:199], v[84:87], v[160:175]
    ds_read_b64_tr_b16 v[184:185], v14 offset:36864
    ds_read_b64_tr_b16 v[186:187], v14 offset:37376
    ds_read_b64_tr_b16 v[188:189], v15 offset:36864
    ds_read_b64_tr_b16 v[190:191], v15 offset:37376
    v_mfma_f32_32x32x16_bf16 v[160:175], v[200:203], v[88:91], v[160:175]
    ds_read_b128 v[96:99], v10 offset:32768
    ds_read_b128 v[100:103], v11 offset:32768
    ds_read_b128 v[104:107], v12 offset:32768
    ds_read_b128 v[108:111], v13 offset:32768
    v_mfma_f32_32x32x16_bf16 v[160:175], v[204:207], v[92:95], v[160:175]
    v_mfma_f32_16x16x32_bf16 v[20:23], v[28:31], v[192:195], v[20:23]
    v_mfma_f32_16x16x32_bf16 v[20:23], v[28:31], v[200:203], v[20:23]
    s_xor_b32 s82, s64, 896
    s_add_u32 m0, s63, 122880
    s_mul_i32 s59, s82, 1536
    buffer_load_dwordx4 v8, s[8:11], s82 offen  lds
    s_add_u32 m0, s63, 57344
    s_nop 0
    buffer_load_dwordx4 v9, s[12:15], s59 offen  lds
    s_waitcnt vmcnt(4)
    s_barrier
    s_waitcnt lgkmcnt(0)
    v_mfma_f32_32x32x16_bf16 v[160:175], v[176:179], v[96:99], v[160:175]
    ds_read_b64_tr_b16 v[192:193], v14 offset:40960
    ds_read_b64_tr_b16 v[194:195], v14 offset:41472
    ds_read_b64_tr_b16 v[196:197], v15 offset:40960
    ds_read_b64_tr_b16 v[198:199], v15 offset:41472
    v_mfma_f32_32x32x16_bf16 v[160:175], v[180:183], v[100:103], v[160:175]
    ds_read_b64_tr_b16 v[200:201], v14 offset:45056
    ds_read_b64_tr_b16 v[202:203], v14 offset:45568
    ds_read_b64_tr_b16 v[204:205], v15 offset:45056
    ds_read_b64_tr_b16 v[206:207], v15 offset:45568
    v_mfma_f32_32x32x16_bf16 v[160:175], v[184:187], v[104:107], v[160:175]
    ds_read_b128 v[112:115], v10 offset:40960
    ds_read_b128 v[116:119], v11 offset:40960
    ds_read_b128 v[120:123], v12 offset:40960
    ds_read_b128 v[124:127], v13 offset:40960
    v_mfma_f32_32x32x16_bf16 v[160:175], v[188:191], v[108:111], v[160:175]
    v_mfma_f32_16x16x32_bf16 v[20:23], v[28:31], v[176:179], v[20:23]
    v_mfma_f32_16x16x32_bf16 v[20:23], v[28:31], v[184:187], v[20:23]
    v_add_u32 v9, 1024, v9
    s_add_u32 m0, s63, 0
    s_nop 0
    buffer_load_dwordx4 v9, s[12:15], s52 offen  lds
    s_add_u32 m0, s63, 8192
    s_nop 0
    buffer_load_dwordx4 v9, s[12:15], s53 offen  lds
    s_waitcnt vmcnt(4)
    s_barrier
    s_waitcnt lgkmcnt(0)
    v_mfma_f32_32x32x16_bf16 v[160:175], v[192:195], v[112:115], v[160:175]
    ds_read_b64_tr_b16 v[176:177], v14 offset:49152
    ds_read_b64_tr_b16 v[178:179], v14 offset:49664
    ds_read_b64_tr_b16 v[180:181], v15 offset:49152
    ds_read_b64_tr_b16 v[182:183], v15 offset:49664
    v_mfma_f32_32x32x16_bf16 v[160:175], v[196:199], v[116:119], v[160:175]
    ds_read_b64_tr_b16 v[184:185], v14 offset:53248
    ds_read_b64_tr_b16 v[186:187], v14 offset:53760
    ds_read_b64_tr_b16 v[188:189], v15 offset:53248
    ds_read_b64_tr_b16 v[190:191], v15 offset:53760
    v_mfma_f32_32x32x16_bf16 v[160:175], v[200:203], v[120:123], v[160:175]
    ds_read_b128 v[128:131], v10 offset:49152
    ds_read_b128 v[132:135], v11 offset:49152
    ds_read_b128 v[136:139], v12 offset:49152
    ds_read_b128 v[140:143], v13 offset:49152
    v_mfma_f32_32x32x16_bf16 v[160:175], v[204:207], v[124:127], v[160:175]
    v_mfma_f32_16x16x32_bf16 v[20:23], v[28:31], v[192:195], v[20:23]
    v_mfma_f32_16x16x32_bf16 v[20:23], v[28:31], v[200:203], v[20:23]
    s_add_u32 m0, s63, 16384
    s_nop 0
    buffer_load_dwordx4 v9, s[12:15], s54 offen  lds
    s_add_u32 m0, s63, 24576
    s_nop 0
    buffer_load_dwordx4 v9, s[12:15], s55 offen  lds
    s_waitcnt vmcnt(4)
    s_barrier
    s_waitcnt lgkmcnt(0)
    v_mfma_f32_32x32x16_bf16 v[160:175], v[176:179], v[128:131], v[160:175]
    ds_read_b64_tr_b16 v[192:193], v14 offset:57344
    ds_read_b64_tr_b16 v[194:195], v14 offset:57856
    ds_read_b64_tr_b16 v[196:197], v15 offset:57344
    ds_read_b64_tr_b16 v[198:199], v15 offset:57856
    v_mfma_f32_32x32x16_bf16 v[160:175], v[180:183], v[132:135], v[160:175]
    ds_read_b64_tr_b16 v[200:201], v14 offset:61440
    ds_read_b64_tr_b16 v[202:203], v14 offset:61952
    ds_read_b64_tr_b16 v[204:205], v15 offset:61440
    ds_read_b64_tr_b16 v[206:207], v15 offset:61952
    v_mfma_f32_32x32x16_bf16 v[160:175], v[184:187], v[136:139], v[160:175]
    ds_read_b128 v[144:147], v10 offset:57344
    ds_read_b128 v[148:151], v11 offset:57344
    ds_read_b128 v[152:155], v12 offset:57344
    ds_read_b128 v[156:159], v13 offset:57344
    v_mfma_f32_32x32x16_bf16 v[160:175], v[188:191], v[140:143], v[160:175]
    v_mfma_f32_16x16x32_bf16 v[20:23], v[28:31], v[176:179], v[20:23]
    v_mfma_f32_16x16x32_bf16 v[20:23], v[28:31], v[184:187], v[20:23]
    s_add_u32 m0, s63, 32768
    s_nop 0
    buffer_load_dwordx4 v9, s[12:15], s56 offen  lds
    s_add_u32 m0, s63, 40960
    s_nop 0
    buffer_load_dwordx4 v9, s[12:15], s57 offen  lds
    s_waitcnt vmcnt(4) lgkmcnt(0)
    s_barrier
    v_mul_u32_u24 v232, 48, v0
    v_add_u32 v232, 157696, v232
    ds_read_b128 v[208:211], v232
    ds_read_b128 v[212:215], v232 offset:16
    v_mfma_f32_32x32x16_bf16 v[160:175], v[192:195], v[144:147], v[160:175]
    s_add_u32 m0, s63, 49152
    s_nop 0
    buffer_load_dwordx4 v9, s[12:15], s58 offen  lds
    s_add_u32 m0, s63, 57344
    s_nop 0
    buffer_load_dwordx4 v9, s[12:15], s59 offen  lds
    v_mfma_f32_32x32x16_bf16 v[160:175], v[196:199], v[148:151], v[160:175]
    v_subrev_u32 v9, 2048, v9
    s_add_u32 m0, s63, 65536
    s_nop 0
    buffer_load_dwordx4 v9, s[12:15], s52 offen  lds
    s_add_u32 m0, s63, 73728
    v_mfma_f32_32x32x16_bf16 v[160:175], v[200:203], v[152:155], v[160:175]
    buffer_load_dwordx4 v9, s[12:15], s53 offen  lds
    s_waitcnt lgkmcnt(0)
    v_add_f32 v208, v208, v209
    v_add_f32 v210, v210, v211
    v_mfma_f32_32x32x16_bf16 v[160:175], v[204:207], v[156:159], v[160:175]
    v_add_f32 v212, v212, v213
    v_add_f32 v208, v208, v210
    v_mul_f32 v212, 989855744, v212
    v_mul_f32 v208, 989855744, v208
    v_mfma_f32_16x16x32_bf16 v[20:23], v[28:31], v[192:195], v[20:23]
    v_cvt_pk_bf16_f32 v24, -v212, -v212
    v_mfma_f32_16x16x32_bf16 v[20:23], v[28:31], v[200:203], v[20:23]
    v_mov_b64 v[26:27], 0
    v_fma_f32 v208, -v212, v212, v208
    v_xor_b32 v6, 0x80000000, v24
    v_max_f32 v208, 0, v208
    v_and_b32 v6, s76, v6
    s_mov_b32 exec_lo, 0
    v_mov_b32 v24, 0
    s_mov_b32 exec_lo, -1
    v_mov_b32 v25, v24
    v_cvt_pk_bf16_f32 v234, v20, v21
    v_lshlrev_b32 v22, 16, v234
    v_and_b32 v23, s76, v234
    v_sub_f32 v20, v20, v22
    v_sub_f32 v21, v21, v23
    v_cvt_pk_bf16_f32 v20, v22, v20
    v_cvt_pk_bf16_f32 v21, v23, v21
    s_mov_b64 exec, 0xffff
    ds_write2_b32 v19, v20, v21 offset0:0 offset1:32
    s_mov_b64 exec, -1
    s_waitcnt vmcnt(6) lgkmcnt(0)
    s_barrier
    ds_read_b64 v[216:217], v253
    s_add_u32 m0, s63, 81920
    s_nop 0
    buffer_load_dwordx4 v9, s[12:15], s54 offen  lds
    s_add_u32 m0, s63, 90112
    s_nop 0
    buffer_load_dwordx4 v9, s[12:15], s55 offen  lds
    s_add_u32 m0, s63, 98304
    s_nop 0
    buffer_load_dwordx4 v9, s[12:15], s56 offen  lds
    s_add_u32 m0, s63, 106496
    s_nop 0
    buffer_load_dwordx4 v9, s[12:15], s57 offen  lds
    v_mov_b64 v[218:219], 0
    v_cvt_pk_bf16_f32 v209, v208, v208
    v_and_b32 v209, s76, v209
    v_add_f32 v209, 925353388, v209
    v_cvt_pk_bf16_f32 v209, v209, v209
    v_and_b32 v209, s76, v209
    v_sqrt_f32 v209, v209
    s_waitcnt lgkmcnt(0)
    v_mfma_f32_32x32x16_bf16 v[160:175], v[216:219], v[24:27], v[160:175]
    v_lshlrev_b32 v232, 2, v0
    v_cvt_pk_bf16_f32 v209, v209, v209
    v_and_b32 v209, s76, v209
    v_rcp_f32 v7, v209
    v_add_u32 v232, 161280, v232
    ds_write2_b32 v232, v6, v7 offset0:0 offset1:64
    v_add_f32 v18, v214, v215
    s_mov_b32 s69, 0
    v_readfirstlane_b32 s65, v17
    s_nop 0
    s_cmp_lg_u32 s65, 0
    s_cbranch_scc0 L_nonce_spina
L_nonce_oka:
    s_lshl_b32 s79, s65, 1
    s_mul_i32 s80, s67, s65
    v_mul_f32 v160, v7, v160
    v_mul_f32 v161, v7, v161
    v_mul_f32 v162, v7, v162
    v_mul_f32 v163, v7, v163
    v_mul_f32 v164, v7, v164
    v_mul_f32 v165, v7, v165
    v_mul_f32 v166, v7, v166
    v_mul_f32 v167, v7, v167
    v_mul_f32 v168, v7, v168
    v_mul_f32 v169, v7, v169
    v_mul_f32 v170, v7, v170
    v_mul_f32 v171, v7, v171
    v_mul_f32 v172, v7, v172
    v_mul_f32 v173, v7, v173
    v_mul_f32 v174, v7, v174
    v_mul_f32 v175, v7, v175
    v_cvt_pk_bf16_f32 v208, v160, v161
    v_cvt_pk_bf16_f32 v209, v162, v163
    v_cvt_pk_bf16_f32 v210, v164, v165
    v_cvt_pk_bf16_f32 v211, v166, v167
    v_cvt_pk_bf16_f32 v212, v168, v169
    v_cvt_pk_bf16_f32 v213, v170, v171
    v_cvt_pk_bf16_f32 v214, v172, v173
    v_cvt_pk_bf16_f32 v215, v174, v175
    v_add_u32 v14, 65536, v14
    v_add_u32 v15, 65536, v15
    s_waitcnt vmcnt(4) lgkmcnt(0)
    s_barrier
    ds_read_b64_tr_b16 v[176:177], v14 offset:0
    ds_read_b64_tr_b16 v[178:179], v14 offset:512
    ds_read_b64_tr_b16 v[180:181], v15 offset:0
    ds_read_b64_tr_b16 v[182:183], v15 offset:512
    ds_read_b64_tr_b16 v[184:185], v14 offset:4096
    ds_read_b64_tr_b16 v[186:187], v14 offset:4608
    ds_read_b64_tr_b16 v[188:189], v15 offset:4096
    ds_read_b64_tr_b16 v[190:191], v15 offset:4608
    s_add_u32 m0, s63, 114688
    s_nop 0
    buffer_load_dwordx4 v9, s[12:15], s58 offen  lds
    s_add_u32 m0, s63, 122880
    s_nop 0
    buffer_load_dwordx4 v9, s[12:15], s59 offen  lds
    s_add_u32 s3, s81, 0
    v_add_u32 v232, v208, v210
    v_add_u32 v234, v212, v214
    buffer_store_dwordx4 v[208:211], v2, s[16:19], s3 offen sc1
    buffer_store_dwordx4 v[212:215], v2, s[16:19], s3 offen offset:1024 sc1
    v_add_u32_dpp v233, v232, v232 row_ror:8 row_mask:0xf bank_mask:0xf
    v_add_u32_dpp v235, v234, v234 row_ror:8 row_mask:0xf bank_mask:0xf
    s_nop 0
    v_add_u32_dpp v232, v233, v233 row_ror:4 row_mask:0xf bank_mask:0xf
    v_add_u32_dpp v234, v235, v235 row_ror:4 row_mask:0xf bank_mask:0xf
    s_nop 0
    v_add_u32_dpp v233, v232, v232 row_ror:2 row_mask:0xf bank_mask:0xf
    v_add_u32_dpp v235, v234, v234 row_ror:2 row_mask:0xf bank_mask:0xf
    s_nop 0
    v_add_u32_dpp v232, v233, v233 row_ror:1 row_mask:0xf bank_mask:0xf
    v_add_u32_dpp v234, v235, v235 row_ror:1 row_mask:0xf bank_mask:0xf
    s_nop 1
    v_mov_b32_dpp v232, v234 quad_perm:[0,1,2,3] row_mask:0xf bank_mask:0xc
    v_and_b32 v233, 8, v1
    v_lshl_add_u32 v233, v233, 1, v4
    s_lshl_b32 s3, s70, 5
    v_sub_u32 v232, s65, v232
    buffer_store_dword v232, v233, s[16:19], s3 offen offset:0 sc1
    s_waitcnt lgkmcnt(0)
    v_mfma_f32_32x32x16_bf16 v[160:175], v[176:179], v[32:35], 0
    ds_read_b64_tr_b16 v[192:193], v14 offset:8192
    ds_read_b64_tr_b16 v[194:195], v14 offset:8704
    ds_read_b64_tr_b16 v[196:197], v15 offset:8192
    ds_read_b64_tr_b16 v[198:199], v15 offset:8704
    v_mfma_f32_32x32x16_bf16 v[160:175], v[180:183], v[36:39], v[160:175]
    ds_read_b64_tr_b16 v[200:201], v14 offset:12288
    ds_read_b64_tr_b16 v[202:203], v14 offset:12800
    ds_read_b64_tr_b16 v[204:205], v15 offset:12288
    ds_read_b64_tr_b16 v[206:207], v15 offset:12800
    v_mfma_f32_32x32x16_bf16 v[160:175], v[184:187], v[40:43], v[160:175]
    s_lshl1_add_u32 s3, s71, 147456
    v_add_u32 v232, s3, v2
    ds_write_b128 v232, v[208:211]
    v_mfma_f32_32x32x16_bf16 v[160:175], v[188:191], v[44:47], v[160:175]
    ds_write_b128 v232, v[212:215] offset:1024
    s_lshl1_add_u32 m0, s71, 131072
    s_nop 0
    buffer_load_dwordx4 v16, s[32:35], s88 offen nt lds
    v_mfma_f32_16x16x32_bf16 v[20:23], v[28:31], v[176:179], 0
    s_lshl1_add_u32 m0, s71, 132096
    v_mfma_f32_16x16x32_bf16 v[20:23], v[28:31], v[184:187], v[20:23]
    buffer_load_dwordx4 v16, s[32:35], s89 offen nt lds
    s_lshl1_add_u32 m0, s71, 139264
    s_nop 0
    buffer_load_dwordx4 v16, s[36:39], s88 offen nt lds
    s_lshl1_add_u32 m0, s71, 140288
    s_nop 0
    buffer_load_dwordx4 v16, s[36:39], s89 offen nt lds
    s_lshr_b32 s4, s96, s85
    s_bitcmp1_b32 s4, 2
    s_cbranch_scc0 L_cand_ret
    v_add_u32 v232, 155648, v2
    ds_read_b128 v[216:219], v232
    v_mov_b32 v234, 0
    s_waitcnt lgkmcnt(0)
    v_dot2c_f32_bf16 v234, s90, v216
    v_dot2c_f32_bf16 v234, s90, v217
    v_dot2c_f32_bf16 v234, s90, v218
    v_dot2c_f32_bf16 v234, s90, v219
    s_nop 2
    v_add_f32_dpp v235, v234, v234 row_ror:8 row_mask:0xf bank_mask:0xf
    s_nop 1
    v_add_f32_dpp v234, v235, v235 row_ror:4 row_mask:0xf bank_mask:0xf
    s_nop 1
    v_add_f32_dpp v235, v234, v234 row_ror:2 row_mask:0xf bank_mask:0xf
    s_nop 1
    v_add_f32_dpp v234, v235, v235 row_ror:1 row_mask:0xf bank_mask:0xf
    v_mov_b32 v235, v234
    s_nop 1
    v_permlane16_swap_b32 v234, v235
    v_add_f32 v234, v234, v235
    v_mov_b32 v235, v234
    s_nop 1
    v_permlane32_swap_b32 v234, v235
    v_add_f32 v234, v234, v235
    v_fma_f32 v18, -v6, v234, v18
    v_mul_f32 v18, v7, v18
    v_cvt_pk_bf16_f32 v18, v18, v18
    v_and_b32 v18, s76, v18
    v_ashrrev_i32 v234, 31, v18
    v_or_b32 v234, 0x80000000, v234
    v_xor_b32 v234, v234, v18
    s_lshl_b32 s3, s60, 6
    s_sub_u32 s3, 2047, s3
    v_sub_u32 v235, s3, v0
    v_and_or_b32 v216, v234, s76, v235
    v_mov_b32 v234, v216
    s_nop 1
    v_max_u32_dpp v235, v234, v234 row_ror:8 row_mask:0xf bank_mask:0xf
    s_nop 1
    v_max_u32_dpp v234, v235, v235 row_ror:4 row_mask:0xf bank_mask:0xf
    s_nop 1
    v_max_u32_dpp v235, v234, v234 row_ror:2 row_mask:0xf bank_mask:0xf
    s_nop 1
    v_max_u32_dpp v234, v235, v235 row_ror:1 row_mask:0xf bank_mask:0xf
    s_nop 0
    v_readlane_b32 s3, v234, 0
    v_readlane_b32 s4, v234, 16
    v_mov_b32 v217, v6
    v_mov_b32 v218, v7
    v_mov_b32 v219, s65
    s_max_u32 s3, s3, s4
    v_cmp_eq_u32 vcc, s3, v216
    s_lshl3_add_u32 s5, s60, s84
    s_lshl_b32 s5, s5, 4
    s_add_u32 s5, s5, 6422528
    s_mov_b64 exec, vcc
    buffer_store_dwordx4 v[216:219], v3, s[16:19], s5 offen sc1
    s_mov_b64 exec, -1
L_cand_ret:
    s_waitcnt vmcnt(11)
    s_barrier
    s_waitcnt lgkmcnt(2)
    v_mfma_f32_32x32x16_bf16 v[160:175], v[192:195], v[48:51], v[160:175]
    ds_read_b64_tr_b16 v[176:177], v14 offset:16384
    ds_read_b64_tr_b16 v[178:179], v14 offset:16896
    ds_read_b64_tr_b16 v[180:181], v15 offset:16384
    ds_read_b64_tr_b16 v[182:183], v15 offset:16896
    v_mfma_f32_32x32x16_bf16 v[160:175], v[196:199], v[52:55], v[160:175]
    ds_read_b64_tr_b16 v[184:185], v14 offset:20480
    ds_read_b64_tr_b16 v[186:187], v14 offset:20992
    ds_read_b64_tr_b16 v[188:189], v15 offset:20480
    ds_read_b64_tr_b16 v[190:191], v15 offset:20992
    v_mfma_f32_32x32x16_bf16 v[160:175], v[200:203], v[56:59], v[160:175]
    v_bfe_u32 v17, v1, 4, 2
    v_lshlrev_b32 v17, 5, v17
    v_xor_b32 v17, v17, v247
    v_mfma_f32_32x32x16_bf16 v[160:175], v[204:207], v[60:63], v[160:175]
    v_mul_f32 v18, 1052289595, v7
    v_mfma_f32_16x16x32_bf16 v[20:23], v[28:31], v[192:195], v[20:23]
    v_mfma_f32_16x16x32_bf16 v[20:23], v[28:31], v[200:203], v[20:23]
    s_waitcnt lgkmcnt(0)
    v_mfma_f32_32x32x16_bf16 v[160:175], v[176:179], v[64:67], v[160:175]
    ds_read_b64_tr_b16 v[192:193], v14 offset:24576
    ds_read_b64_tr_b16 v[194:195], v14 offset:25088
    ds_read_b64_tr_b16 v[196:197], v15 offset:24576
    ds_read_b64_tr_b16 v[198:199], v15 offset:25088
    v_mfma_f32_32x32x16_bf16 v[160:175], v[180:183], v[68:71], v[160:175]
    ds_read_b64_tr_b16 v[200:201], v14 offset:28672
    ds_read_b64_tr_b16 v[202:203], v14 offset:29184
    ds_read_b64_tr_b16 v[204:205], v15 offset:28672
    ds_read_b64_tr_b16 v[206:207], v15 offset:29184
    v_mfma_f32_32x32x16_bf16 v[160:175], v[184:187], v[72:75], v[160:175]
    v_mfma_f32_32x32x16_bf16 v[160:175], v[188:191], v[76:79], v[160:175]
    v_mfma_f32_16x16x32_bf16 v[20:23], v[28:31], v[176:179], v[20:23]
    v_mfma_f32_16x16x32_bf16 v[20:23], v[28:31], v[184:187], v[20:23]
    s_waitcnt vmcnt(9)
    s_barrier
    s_waitcnt lgkmcnt(0)
    v_mfma_f32_32x32x16_bf16 v[160:175], v[192:195], v[80:83], v[160:175]
    ds_read_b64_tr_b16 v[176:177], v14 offset:32768
    ds_read_b64_tr_b16 v[178:179], v14 offset:33280
    ds_read_b64_tr_b16 v[180:181], v15 offset:32768
    ds_read_b64_tr_b16 v[182:183], v15 offset:33280
    v_mfma_f32_32x32x16_bf16 v[160:175], v[196:199], v[84:87], v[160:175]
    ds_read_b64_tr_b16 v[184:185], v14 offset:36864
    ds_read_b64_tr_b16 v[186:187], v14 offset:37376
    ds_read_b64_tr_b16 v[188:189], v15 offset:36864
    ds_read_b64_tr_b16 v[190:191], v15 offset:37376
    v_mfma_f32_32x32x16_bf16 v[160:175], v[200:203], v[88:91], v[160:175]
    v_mfma_f32_32x32x16_bf16 v[160:175], v[204:207], v[92:95], v[160:175]
    v_mfma_f32_16x16x32_bf16 v[20:23], v[28:31], v[192:195], v[20:23]
    v_mfma_f32_16x16x32_bf16 v[20:23], v[28:31], v[200:203], v[20:23]
    s_waitcnt lgkmcnt(0)
    v_mfma_f32_32x32x16_bf16 v[160:175], v[176:179], v[96:99], v[160:175]
    ds_read_b64_tr_b16 v[192:193], v14 offset:40960
    ds_read_b64_tr_b16 v[194:195], v14 offset:41472
    ds_read_b64_tr_b16 v[196:197], v15 offset:40960
    ds_read_b64_tr_b16 v[198:199], v15 offset:41472
    v_mfma_f32_32x32x16_bf16 v[160:175], v[180:183], v[100:103], v[160:175]
    ds_read_b64_tr_b16 v[200:201], v14 offset:45056
    ds_read_b64_tr_b16 v[202:203], v14 offset:45568
    ds_read_b64_tr_b16 v[204:205], v15 offset:45056
    ds_read_b64_tr_b16 v[206:207], v15 offset:45568
    v_mfma_f32_32x32x16_bf16 v[160:175], v[184:187], v[104:107], v[160:175]
    v_mov_b64 v[36:37], s[90:91]
    v_mov_b64 v[38:39], s[90:91]
    v_mov_b64 v[44:45], s[90:91]
    v_mfma_f32_32x32x16_bf16 v[160:175], v[188:191], v[108:111], v[160:175]
    v_mov_b64 v[46:47], s[90:91]
    v_mov_b64 v[52:53], s[90:91]
    v_mov_b64 v[54:55], s[90:91]
    v_mfma_f32_16x16x32_bf16 v[20:23], v[28:31], v[176:179], v[20:23]
    v_mov_b64 v[60:61], s[90:91]
    v_mfma_f32_16x16x32_bf16 v[20:23], v[28:31], v[184:187], v[20:23]
    v_mov_b64 v[62:63], s[90:91]
    s_waitcnt vmcnt(7)
    s_barrier
    s_waitcnt lgkmcnt(0)
    v_mfma_f32_32x32x16_bf16 v[160:175], v[192:195], v[112:115], v[160:175]
    ds_read_b64_tr_b16 v[176:177], v14 offset:49152
    ds_read_b64_tr_b16 v[178:179], v14 offset:49664
    ds_read_b64_tr_b16 v[180:181], v15 offset:49152
    ds_read_b64_tr_b16 v[182:183], v15 offset:49664
    v_mfma_f32_32x32x16_bf16 v[160:175], v[196:199], v[116:119], v[160:175]
    ds_read_b64_tr_b16 v[184:185], v14 offset:53248
    ds_read_b64_tr_b16 v[186:187], v14 offset:53760
    ds_read_b64_tr_b16 v[188:189], v15 offset:53248
    ds_read_b64_tr_b16 v[190:191], v15 offset:53760
    v_mfma_f32_32x32x16_bf16 v[160:175], v[200:203], v[120:123], v[160:175]
    v_mov_b64 v[68:69], s[90:91]
    v_mov_b64 v[70:71], s[90:91]
    v_mfma_f32_32x32x16_bf16 v[160:175], v[204:207], v[124:127], v[160:175]
    v_mfma_f32_16x16x32_bf16 v[20:23], v[28:31], v[192:195], v[20:23]
    v_mfma_f32_16x16x32_bf16 v[20:23], v[28:31], v[200:203], v[20:23]
    s_waitcnt lgkmcnt(0)
    v_mfma_f32_32x32x16_bf16 v[160:175], v[176:179], v[128:131], v[160:175]
    ds_read_b64_tr_b16 v[192:193], v14 offset:57344
    ds_read_b64_tr_b16 v[194:195], v14 offset:57856
    ds_read_b64_tr_b16 v[196:197], v15 offset:57344
    ds_read_b64_tr_b16 v[198:199], v15 offset:57856
    v_mfma_f32_32x32x16_bf16 v[160:175], v[180:183], v[132:135], v[160:175]
    ds_read_b64_tr_b16 v[200:201], v14 offset:61440
    ds_read_b64_tr_b16 v[202:203], v14 offset:61952
    ds_read_b64_tr_b16 v[204:205], v15 offset:61440
    ds_read_b64_tr_b16 v[206:207], v15 offset:61952
    v_mfma_f32_32x32x16_bf16 v[160:175], v[184:187], v[136:139], v[160:175]
    v_mfma_f32_32x32x16_bf16 v[160:175], v[188:191], v[140:143], v[160:175]
    v_mfma_f32_16x16x32_bf16 v[20:23], v[28:31], v[176:179], v[20:23]
    v_mfma_f32_16x16x32_bf16 v[20:23], v[28:31], v[184:187], v[20:23]
    s_waitcnt lgkmcnt(0)
    v_mfma_f32_32x32x16_bf16 v[160:175], v[192:195], v[144:147], v[160:175]
    v_mfma_f32_32x32x16_bf16 v[160:175], v[196:199], v[148:151], v[160:175]
    v_mfma_f32_32x32x16_bf16 v[160:175], v[200:203], v[152:155], v[160:175]
    v_mfma_f32_32x32x16_bf16 v[160:175], v[204:207], v[156:159], v[160:175]
    v_mfma_f32_16x16x32_bf16 v[20:23], v[28:31], v[192:195], v[20:23]
    v_mfma_f32_16x16x32_bf16 v[20:23], v[28:31], v[200:203], v[20:23]
    s_nop 7
    v_cvt_pk_bf16_f32 v234, v20, v21
    v_lshlrev_b32 v22, 16, v234
    v_and_b32 v23, s76, v234
    v_sub_f32 v20, v20, v22
    v_sub_f32 v21, v21, v23
    v_cvt_pk_bf16_f32 v20, v22, v20
    v_cvt_pk_bf16_f32 v21, v23, v21
    s_mov_b64 exec, 0xffff
    ds_write2_b32 v19, v20, v21 offset0:0 offset1:32
    s_mov_b64 exec, -1
    s_waitcnt vmcnt(0) lgkmcnt(0)
    s_barrier
    ds_read_b64 v[240:241], v253
    v_mov_b64 v[242:243], 0
    s_waitcnt lgkmcnt(0)
    s_nop 0
    v_mfma_f32_32x32x16_bf16 v[160:175], v[240:243], v[24:27], v[160:175]
    s_add_u32 s3, s63, 32768
    v_add_u32 v235, s3, v2
    v_add_u32 v234, 114688, v235
    ds_read_b128 v[176:179], v234
    ds_read_b128 v[32:35], v235
    v_mov_b32 v12, v235
    v_mov_b64 v[136:137], 0
    v_mov_b64 v[138:139], 0
    v_mov_b64 v[140:141], 0
    v_mov_b64 v[142:143], 0
    v_mov_b64 v[144:145], 0
    v_xor_b32 v234, 4096, v235
    s_lshl1_add_u32 s3, s71, 40960
    v_add_u32 v232, s3, v2
    v_mul_f32 v160, v18, v160
    v_mul_f32 v161, v18, v161
    v_mul_f32 v162, v18, v162
    v_mul_f32 v163, v18, v163
    v_mul_f32 v164, v18, v164
    v_mul_f32 v165, v18, v165
    v_mul_f32 v166, v18, v166
    v_mul_f32 v167, v18, v167
    v_cvt_pk_bf16_f32 v72, v160, v161
    v_cvt_pk_bf16_f32 v73, v162, v163
    v_cvt_pk_bf16_f32 v74, v164, v165
    v_cvt_pk_bf16_f32 v75, v166, v167
    ds_write_b128 v232, v[72:75] offset:0
    v_mul_f32 v168, v18, v168
    v_mul_f32 v169, v18, v169
    v_mul_f32 v170, v18, v170
    v_mul_f32 v171, v18, v171
    v_mul_f32 v172, v18, v172
    v_mul_f32 v173, v18, v173
    v_mul_f32 v174, v18, v174
    v_mul_f32 v175, v18, v175
    v_cvt_pk_bf16_f32 v76, v168, v169
    v_cvt_pk_bf16_f32 v77, v170, v171
    v_cvt_pk_bf16_f32 v78, v172, v173
    v_cvt_pk_bf16_f32 v79, v174, v175
    ds_write_b128 v232, v[76:79] offset:1024
    s_waitcnt lgkmcnt(0)
    s_barrier
    ds_read_b128 v[168:171], v235 offset:8192
    ds_read_b128 v[172:175], v234 offset:8192
    buffer_load_dwordx4 v[208:211], v2, s[16:19], s48 offen
    v_permlane16_swap_b32 v32, v36
    buffer_load_dwordx4 v[212:215], v2, s[16:19], s49 offen
    v_permlane16_swap_b32 v33, v37
    buffer_load_dwordx4 v[216:219], v2, s[16:19], s50 offen
    v_permlane16_swap_b32 v34, v38
    buffer_load_dwordx4 v[220:223], v2, s[16:19], s51 offen
    v_permlane16_swap_b32 v35, v39
    s_waitcnt lgkmcnt(1)
    v_mfma_f32_32x32x16_bf16 v[72:87], v[176:179], v[168:171], 0
    s_waitcnt lgkmcnt(0)
    v_mfma_f32_32x32x16_bf16 v[88:103], v[176:179], v[172:175], 0
    s_nop 9
    v_exp_f32 v72, v72
    buffer_load_dword v254, v244, s[16:19], 0 offen
    v_exp_f32 v73, v73
    v_exp_f32 v74, v74
    v_exp_f32 v75, v75
    buffer_load_dwordx4 v[40:43], v246, s[16:19], s48 offen
    v_exp_f32 v76, v76
    v_exp_f32 v77, v77
    v_exp_f32 v78, v78
    buffer_load_dwordx4 v[48:51], v246, s[16:19], s49 offen
    v_exp_f32 v79, v79
    v_exp_f32 v80, v80
    v_cvt_pk_bf16_f32 v152, v72, v73
    buffer_load_dwordx4 v[56:59], v246, s[16:19], s50 offen
    v_cvt_pk_bf16_f32 v153, v74, v75
    v_cvt_pk_bf16_f32 v154, v76, v77
    v_cvt_pk_bf16_f32 v155, v78, v79
    buffer_load_dwordx4 v[64:67], v246, s[16:19], s51 offen
    v_and_b32 v152, v224, v152
    v_and_b32 v153, v225, v153
    v_and_b32 v154, v226, v154
    buffer_load_dword v255, v244, s[16:19], 0 offen offset:128
    v_and_b32 v155, v227, v155
    v_exp_f32 v81, v81
    v_exp_f32 v82, v82
    v_mfma_f32_32x32x16_bf16 v[120:135], v[32:35], v[152:155], 0
    v_exp_f32 v83, v83
    v_exp_f32 v84, v84
    v_exp_f32 v85, v85
    v_exp_f32 v86, v86
    v_exp_f32 v87, v87
    v_cvt_pk_bf16_f32 v156, v80, v81
    v_cvt_pk_bf16_f32 v157, v82, v83
    v_cvt_pk_bf16_f32 v158, v84, v85
    v_cvt_pk_bf16_f32 v159, v86, v87
    v_and_b32 v156, v228, v156
    v_and_b32 v157, v229, v157
    v_and_b32 v158, v230, v158
    v_and_b32 v159, v231, v159
    s_nop 1
    v_mfma_f32_32x32x16_bf16 v[120:135], v[36:39], v[156:159], v[120:135]
    v_exp_f32 v88, v88
    v_exp_f32 v89, v89
    v_exp_f32 v90, v90
    v_exp_f32 v91, v91
    v_exp_f32 v92, v92
    v_exp_f32 v93, v93
    v_exp_f32 v94, v94
    v_exp_f32 v95, v95
    v_exp_f32 v96, v96
    v_cvt_pk_bf16_f32 v160, v88, v89
    v_cvt_pk_bf16_f32 v161, v90, v91
    v_cvt_pk_bf16_f32 v162, v92, v93
    v_cvt_pk_bf16_f32 v163, v94, v95
    v_exp_f32 v97, v97
    v_exp_f32 v98, v98
    v_mfma_f32_32x32x16_bf16 v[136:151], v[32:35], v[160:163], v[136:151]
    v_exp_f32 v99, v99
    v_exp_f32 v100, v100
    v_exp_f32 v101, v101
    v_exp_f32 v102, v102
    v_exp_f32 v103, v103
    v_cvt_pk_bf16_f32 v164, v96, v97
    v_cvt_pk_bf16_f32 v165, v98, v99
    v_cvt_pk_bf16_f32 v166, v100, v101
    v_cvt_pk_bf16_f32 v167, v102, v103
    s_nop 1
    v_mfma_f32_32x32x16_bf16 v[136:151], v[36:39], v[164:167], v[136:151]
    buffer_load_dword v13, v3, s[8:11], 0 offen
L_afterB0:
    s_waitcnt lgkmcnt(0)
    s_mov_b32 s69, 0
    s_waitcnt vmcnt(6)
L_kval:
    v_mfma_f32_32x32x16_bf16 v[72:87], v[208:211], v[168:171], 0
    v_mfma_f32_32x32x16_bf16 v[88:103], v[208:211], v[172:175], 0
    v_add3_u32 v232, v208, v210, v212
    v_add3_u32 v232, v232, v214, v216
    v_add3_u32 v232, v232, v218, v220
    v_add3_u32 v232, v232, v222, v254
    s_nop 1
    v_add_u32_dpp v233, v232, v232 row_ror:8 row_mask:0xf bank_mask:0xf
    s_nop 1
    v_add_u32_dpp v232, v233, v233 row_ror:4 row_mask:0xf bank_mask:0xf
    s_nop 1
    v_add_u32_dpp v233, v232, v232 row_ror:2 row_mask:0xf bank_mask:0xf
    s_nop 1
    v_add_u32_dpp v232, v233, v233 row_ror:1 row_mask:0xf bank_mask:0xf
    v_cmp_ne_u32 vcc, s80, v232
    s_nop 0
    s_cbranch_vccnz L_kretry
L_kok:
    s_mov_b32 s69, 0
    s_waitcnt vmcnt(1)
L_vvale:
    v_add3_u32 v232, v40, v42, v48
    v_add3_u32 v232, v232, v50, v56
    v_add3_u32 v232, v232, v58, v64
    v_add3_u32 v232, v232, v66, v255
    s_nop 1
    v_add_u32_dpp v233, v232, v232 row_ror:8 row_mask:0xf bank_mask:0xf
    s_nop 1
    v_add_u32_dpp v232, v233, v233 row_ror:4 row_mask:0xf bank_mask:0xf
    s_nop 1
    v_add_u32_dpp v233, v232, v232 row_ror:2 row_mask:0xf bank_mask:0xf
    s_nop 1
    v_add_u32_dpp v232, v233, v233 row_ror:1 row_mask:0xf bank_mask:0xf
    v_cmp_ne_u32 vcc, s80, v232
    s_nop 0
    s_cbranch_vccnz L_vretrye
L_voke:
    v_permlane16_swap_b32 v40, v44
    v_permlane16_swap_b32 v41, v45
    v_permlane16_swap_b32 v42, v46
    v_permlane16_swap_b32 v43, v47
    v_permlane16_swap_b32 v48, v52
    v_permlane16_swap_b32 v49, v53
    v_permlane16_swap_b32 v50, v54
    v_permlane16_swap_b32 v51, v55
    v_permlane16_swap_b32 v56, v60
    v_permlane16_swap_b32 v57, v61
    v_permlane16_swap_b32 v58, v62
    v_permlane16_swap_b32 v59, v63
    v_permlane16_swap_b32 v64, v68
    v_permlane16_swap_b32 v65, v69
    v_permlane16_swap_b32 v66, v70
    v_permlane16_swap_b32 v67, v71
    s_cmp_eq_u32 s68, 0
    s_cbranch_scc1 L_att_g0
    s_cmp_lt_u32 s67, 1
    s_cbranch_scc1 L_g1b_x1
    v_exp_f32 v88, v88
    v_exp_f32 v89, v89
    v_exp_f32 v90, v90
    v_exp_f32 v91, v91
    v_exp_f32 v92, v92
    v_mfma_f32_32x32x16_bf16 v[72:87], v[212:215], v[172:175], 0
    v_exp_f32 v93, v93
    v_exp_f32 v94, v94
    v_exp_f32 v95, v95
    v_exp_f32 v96, v96
    s_add_u32 m0, s63, 0
    s_add_u32 s82, s78, 0
    buffer_load_dwordx4 v17, s[28:31], s82 offen  lds
    s_add_u32 m0, s63, 8192
    s_add_u32 s82, s78, 65536
    buffer_load_dwordx4 v17, s[28:31], s82 offen  lds
    v_cvt_pk_bf16_f32 v160, v88, v89
    v_cvt_pk_bf16_f32 v161, v90, v91
    v_cvt_pk_bf16_f32 v162, v92, v93
    v_cvt_pk_bf16_f32 v163, v94, v95
    v_exp_f32 v97, v97
    v_exp_f32 v98, v98
    v_mfma_f32_32x32x16_bf16 v[136:151], v[40:43], v[160:163], v[136:151]
    v_exp_f32 v99, v99
    v_exp_f32 v100, v100
    v_exp_f32 v101, v101
    v_exp_f32 v102, v102
    v_exp_f32 v103, v103
    s_lshl_b32 s3, s70, 7
    s_add_u32 s3, s3, 161792
    v_and_b32 v232, 31, v1
    v_lshl_add_u32 v232, v232, 2, s3
    s_waitcnt vmcnt(2)
    v_lshlrev_b32 v236, 16, v13
    v_and_b32 v237, s76, v13
    v_subrev_f32 v236, s98, v236
    v_subrev_f32 v237, s98, v237
    v_cvt_pk_bf16_f32 v238, v236, v237
    v_lshlrev_b32 v236, 16, v238
    v_and_b32 v237, s76, v238
    v_mul_f32 v236, s99, v236
    v_mul_f32 v237, s99, v237
    v_cvt_pk_bf16_f32 v238, v236, v237
    ds_write_b32 v232, v238
    s_lshl_b32 s3, s70, 5
    s_add_u32 s3, s3, 131072
    v_xor_b32 v233, s3, v250
    ds_read_b64_tr_b16 v[104:105], v233 offset:0
    ds_read_b64_tr_b16 v[106:107], v233 offset:1024
    ds_read_b64_tr_b16 v[108:109], v233 offset:4096
    ds_read_b64_tr_b16 v[110:111], v233 offset:5120
    ds_read_b64_tr_b16 v[112:113], v233 offset:8192
    ds_read_b64_tr_b16 v[114:115], v233 offset:9216
    ds_read_b64_tr_b16 v[116:117], v233 offset:12288
    ds_read_b64_tr_b16 v[118:119], v233 offset:13312
    s_lshl_b32 s3, s70, 7
    s_add_u32 s3, s3, 161792
    v_lshrrev_b32 v232, 5, v1
    v_bfe_u32 v233, v1, 4, 1
    v_lshlrev_b32 v233, 3, v233
    v_lshl_add_u32 v232, v232, 5, v233
    v_add_u32 v232, s3, v232
    ds_read_b64 v[184:185], v232 offset:0
    ds_read_b64 v[186:187], v232 offset:16
    ds_read_b64 v[188:189], v232 offset:64
    ds_read_b64 v[190:191], v232 offset:80
    s_lshl3_add_u32 s3, s74, s86
    s_lshl2_add_u32 s3, s3, s70
    s_lshl_b32 s3, s3, 8
    s_add_u32 s3, s3, 6619136
    s_cmp_ge_u32 s74, 22
    s_cselect_b32 s3, 1073741824, s3
    s_waitcnt lgkmcnt(0)
    v_mfma_f32_16x16x32_bf16 v[192:195], v[184:187], v[104:107], 0
    v_mfma_f32_16x16x32_bf16 v[196:199], v[184:187], v[112:115], 0
    v_mfma_f32_16x16x32_bf16 v[192:195], v[188:191], v[108:111], v[192:195]
    v_mfma_f32_16x16x32_bf16 v[196:199], v[188:191], v[116:119], v[196:199]
    s_nop 6
    v_mov_b32 v193, s65
    v_mov_b32 v194, v196
    v_mov_b32 v195, s65
    s_mov_b64 exec, 0xffff
    buffer_store_dwordx4 v[192:195], v2, s[16:19], s3 offen sc1
    s_mov_b64 exec, -1
    v_cvt_pk_bf16_f32 v164, v96, v97
    v_cvt_pk_bf16_f32 v165, v98, v99
    v_cvt_pk_bf16_f32 v166, v100, v101
    v_cvt_pk_bf16_f32 v167, v102, v103
    s_cmp_lt_u32 s67, 2
    s_cbranch_scc1 L_g1b_x2
    v_exp_f32 v72, v72
    v_exp_f32 v73, v73
    v_mfma_f32_32x32x16_bf16 v[136:151], v[44:47], v[164:167], v[136:151]
    v_exp_f32 v74, v74
    v_exp_f32 v75, v75
    v_exp_f32 v76, v76
    v_mfma_f32_32x32x16_bf16 v[88:103], v[216:219], v[172:175], 0
    v_exp_f32 v77, v77
    v_exp_f32 v78, v78
    v_exp_f32 v79, v79
    v_exp_f32 v80, v80
    s_add_u32 m0, s63, 16384
    s_add_u32 s82, s78, 131072
    buffer_load_dwordx4 v17, s[28:31], s82 offen  lds
    s_add_u32 m0, s63, 24576
    s_add_u32 s82, s78, 196608
    buffer_load_dwordx4 v17, s[28:31], s82 offen  lds
    v_cvt_pk_bf16_f32 v152, v72, v73
    v_cvt_pk_bf16_f32 v153, v74, v75
    v_cvt_pk_bf16_f32 v154, v76, v77
    v_cvt_pk_bf16_f32 v155, v78, v79
    v_exp_f32 v81, v81
    v_exp_f32 v82, v82
    v_mfma_f32_32x32x16_bf16 v[136:151], v[48:51], v[152:155], v[136:151]
    v_exp_f32 v83, v83
    v_exp_f32 v84, v84
    v_exp_f32 v85, v85
    v_exp_f32 v86, v86
    v_exp_f32 v87, v87
    s_add_u32 m0, s63, 65536
    s_add_u32 s82, s78, 262144
    buffer_load_dwordx4 v17, s[28:31], s82 offen  lds
    s_add_u32 m0, s63, 73728
    s_add_u32 s82, s78, 327680
    buffer_load_dwordx4 v17, s[28:31], s82 offen  lds
    v_cvt_pk_bf16_f32 v156, v80, v81
    v_cvt_pk_bf16_f32 v157, v82, v83
    v_cvt_pk_bf16_f32 v158, v84, v85
    v_cvt_pk_bf16_f32 v159, v86, v87
    s_cmp_lt_u32 s67, 3
    s_cbranch_scc1 L_g1b_x3
    v_exp_f32 v88, v88
    v_exp_f32 v89, v89
    v_mfma_f32_32x32x16_bf16 v[136:151], v[52:55], v[156:159], v[136:151]
    v_exp_f32 v90, v90
    v_exp_f32 v91, v91
    v_exp_f32 v92, v92
    v_mfma_f32_32x32x16_bf16 v[72:87], v[220:223], v[172:175], 0
    v_exp_f32 v93, v93
    v_exp_f32 v94, v94
    v_exp_f32 v95, v95
    v_exp_f32 v96, v96
    s_add_u32 m0, s63, 81920
    s_add_u32 s82, s78, 393216
    buffer_load_dwordx4 v17, s[28:31], s82 offen  lds
    s_add_u32 m0, s63, 90112
    s_add_u32 s82, s78, 458752
    buffer_load_dwordx4 v17, s[28:31], s82 offen  lds
    v_cvt_pk_bf16_f32 v160, v88, v89
    v_cvt_pk_bf16_f32 v161, v90, v91
    v_cvt_pk_bf16_f32 v162, v92, v93
    v_cvt_pk_bf16_f32 v163, v94, v95
    v_exp_f32 v97, v97
    v_exp_f32 v98, v98
    v_mfma_f32_32x32x16_bf16 v[136:151], v[56:59], v[160:163], v[136:151]
    v_exp_f32 v99, v99
    v_exp_f32 v100, v100
    v_exp_f32 v101, v101
    v_exp_f32 v102, v102
    v_exp_f32 v103, v103
    buffer_load_dwordx4 v[8:11], v247, s[8:11], s77 offen
    v_cvt_pk_bf16_f32 v164, v96, v97
    v_cvt_pk_bf16_f32 v165, v98, v99
    v_cvt_pk_bf16_f32 v166, v100, v101
    v_cvt_pk_bf16_f32 v167, v102, v103
    s_cmp_lt_u32 s67, 4
    s_cbranch_scc1 L_g1b_x4
    v_exp_f32 v72, v72
    v_exp_f32 v73, v73
    v_mfma_f32_32x32x16_bf16 v[136:151], v[60:63], v[164:167], v[136:151]
    v_exp_f32 v74, v74
    v_exp_f32 v75, v75
    v_exp_f32 v76, v76
    v_mfma_f32_32x32x16_bf16 v[88:103], v[208:211], v[168:171], 0
    v_exp_f32 v77, v77
    v_exp_f32 v78, v78
    v_exp_f32 v79, v79
    v_exp_f32 v80, v80
    v_cvt_pk_bf16_f32 v152, v72, v73
    v_cvt_pk_bf16_f32 v153, v74, v75
    v_cvt_pk_bf16_f32 v154, v76, v77
    v_cvt_pk_bf16_f32 v155, v78, v79
    v_exp_f32 v81, v81
    v_exp_f32 v82, v82
    v_mfma_f32_32x32x16_bf16 v[136:151], v[64:67], v[152:155], v[136:151]
    v_exp_f32 v83, v83
    v_exp_f32 v84, v84
    v_exp_f32 v85, v85
    v_exp_f32 v86, v86
    v_exp_f32 v87, v87
    v_cvt_pk_bf16_f32 v156, v80, v81
    v_cvt_pk_bf16_f32 v157, v82, v83
    v_cvt_pk_bf16_f32 v158, v84, v85
    v_cvt_pk_bf16_f32 v159, v86, v87
    s_nop 1
    v_mfma_f32_32x32x16_bf16 v[136:151], v[68:71], v[156:159], v[136:151]
L_g1b_end:
    s_nop 7
    s_nop 3
    v_mov_b32 v145, s65
    ds_write_b128 v12, v[136:139]
    ds_write_b128 v12, v[140:143] offset:16384
    ds_write_b64 v12, v[144:145] offset:24576
    s_setprio 0
    s_cmp_lt_u32 s67, 1
    s_cbranch_scc1 L_g1a_x1
    v_exp_f32 v88, v88
    v_exp_f32 v89, v89
    v_exp_f32 v90, v90
    v_exp_f32 v91, v91
    v_exp_f32 v92, v92
    v_mfma_f32_32x32x16_bf16 v[72:87], v[212:215], v[168:171], 0
    v_exp_f32 v93, v93
    v_exp_f32 v94, v94
    v_exp_f32 v95, v95
    v_exp_f32 v96, v96
    v_cvt_pk_bf16_f32 v160, v88, v89
    v_cvt_pk_bf16_f32 v161, v90, v91
    v_cvt_pk_bf16_f32 v162, v92, v93
    v_cvt_pk_bf16_f32 v163, v94, v95
    v_exp_f32 v97, v97
    v_exp_f32 v98, v98
    v_mfma_f32_32x32x16_bf16 v[120:135], v[40:43], v[160:163], v[120:135]
    v_exp_f32 v99, v99
    v_exp_f32 v100, v100
    v_exp_f32 v101, v101
    v_exp_f32 v102, v102
    v_exp_f32 v103, v103
    v_cvt_pk_bf16_f32 v164, v96, v97
    v_cvt_pk_bf16_f32 v165, v98, v99
    v_cvt_pk_bf16_f32 v166, v100, v101
    v_cvt_pk_bf16_f32 v167, v102, v103
    s_cmp_lt_u32 s67, 2
    s_cbranch_scc1 L_g1a_x2
    v_exp_f32 v72, v72
    v_exp_f32 v73, v73
    v_mfma_f32_32x32x16_bf16 v[120:135], v[44:47], v[164:167], v[120:135]
    v_exp_f32 v74, v74
    v_exp_f32 v75, v75
    v_exp_f32 v76, v76
    v_mfma_f32_32x32x16_bf16 v[88:103], v[216:219], v[168:171], 0
    v_exp_f32 v77, v77
    v_exp_f32 v78, v78
    v_exp_f32 v79, v79
    v_exp_f32 v80, v80
    s_lshl2_add_u32 s3, s62, 162320
    v_mov_b32 v232, s65
    v_mov_b32 v233, s3
    s_waitcnt vmcnt(0)
    ds_write_b32 v233, v232
    v_cvt_pk_bf16_f32 v152, v72, v73
    v_cvt_pk_bf16_f32 v153, v74, v75
    v_cvt_pk_bf16_f32 v154, v76, v77
    v_cvt_pk_bf16_f32 v155, v78, v79
    v_exp_f32 v81, v81
    v_exp_f32 v82, v82
    v_mfma_f32_32x32x16_bf16 v[120:135], v[48:51], v[152:155], v[120:135]
    v_exp_f32 v83, v83
    v_exp_f32 v84, v84
    v_exp_f32 v85, v85
    v_exp_f32 v86, v86
    v_exp_f32 v87, v87
    v_cvt_pk_bf16_f32 v156, v80, v81
    v_cvt_pk_bf16_f32 v157, v82, v83
    v_cvt_pk_bf16_f32 v158, v84, v85
    v_cvt_pk_bf16_f32 v159, v86, v87
    s_cmp_lt_u32 s67, 3
    s_cbranch_scc1 L_g1a_x3
    v_exp_f32 v88, v88
    v_exp_f32 v89, v89
    v_mfma_f32_32x32x16_bf16 v[120:135], v[52:55], v[156:159], v[120:135]
    v_exp_f32 v90, v90
    v_exp_f32 v91, v91
    v_exp_f32 v92, v92
    v_mfma_f32_32x32x16_bf16 v[72:87], v[220:223], v[168:171], 0
    v_exp_f32 v93, v93
    v_exp_f32 v94, v94
    v_exp_f32 v95, v95
    v_exp_f32 v96, v96
    v_cvt_pk_bf16_f32 v160, v88, v89
    v_cvt_pk_bf16_f32 v161, v90, v91
    v_cvt_pk_bf16_f32 v162, v92, v93
    v_cvt_pk_bf16_f32 v163, v94, v95
    v_exp_f32 v97, v97
    v_exp_f32 v98, v98
    v_mfma_f32_32x32x16_bf16 v[120:135], v[56:59], v[160:163], v[120:135]
    v_exp_f32 v99, v99
    v_exp_f32 v100, v100
    v_exp_f32 v101, v101
    v_exp_f32 v102, v102
    v_exp_f32 v103, v103
    v_cvt_pk_bf16_f32 v164, v96, v97
    v_cvt_pk_bf16_f32 v165, v98, v99
    v_cvt_pk_bf16_f32 v166, v100, v101
    v_cvt_pk_bf16_f32 v167, v102, v103
    s_cmp_lt_u32 s67, 4
    s_cbranch_scc1 L_g1a_x4
    v_exp_f32 v72, v72
    v_exp_f32 v73, v73
    v_mfma_f32_32x32x16_bf16 v[120:135], v[60:63], v[164:167], v[120:135]
    v_exp_f32 v74, v74
    v_exp_f32 v75, v75
    v_exp_f32 v76, v76
    v_exp_f32 v77, v77
    v_exp_f32 v78, v78
    v_exp_f32 v79, v79
    v_exp_f32 v80, v80
    v_cvt_pk_bf16_f32 v152, v72, v73
    v_cvt_pk_bf16_f32 v153, v74, v75
    v_cvt_pk_bf16_f32 v154, v76, v77
    v_cvt_pk_bf16_f32 v155, v78, v79
    v_bfi_b32 v152, v224, 0, v152
    v_bfi_b32 v153, v225, 0, v153
    v_bfi_b32 v154, v226, 0, v154
    v_bfi_b32 v155, v227, 0, v155
    v_exp_f32 v81, v81
    v_exp_f32 v82, v82
    v_mfma_f32_32x32x16_bf16 v[120:135], v[64:67], v[152:155], v[120:135]
    v_exp_f32 v83, v83
    v_exp_f32 v84, v84
    v_exp_f32 v85, v85
    v_exp_f32 v86, v86
    v_exp_f32 v87, v87
    v_cvt_pk_bf16_f32 v156, v80, v81
    v_cvt_pk_bf16_f32 v157, v82, v83
    v_cvt_pk_bf16_f32 v158, v84, v85
    v_cvt_pk_bf16_f32 v159, v86, v87
    v_bfi_b32 v156, v228, 0, v156
    v_bfi_b32 v157, v229, 0, v157
    v_bfi_b32 v158, v230, 0, v158
    v_bfi_b32 v159, v231, 0, v159
    s_nop 1
    v_mfma_f32_32x32x16_bf16 v[120:135], v[68:71], v[156:159], v[120:135]
L_g1a_end:
    v_xor_b32 v234, 4096, v12
    s_mov_b32 s69, 0
L_mspinb:
    ds_read_b64 v[112:113], v234 offset:24576
    ds_read_b128 v[104:107], v234
    ds_read_b128 v[108:111], v234 offset:16384
    s_waitcnt lgkmcnt(2)
    v_cmp_ne_u32 vcc, s65, v113
    s_nop 0
    s_cbranch_vccz L_mokb
    s_sleep 1
    s_add_u32 s69, s69, 1
    s_cmp_gt_u32 s69, 65536
    s_cbranch_scc0 L_mspinb
L_mokb:
    s_nop 2
    v_add_f32 v128, v128, v112
    v_subrev_u32 v232, 0x1f800000, v128
    v_cmp_lt_u32 vcc, 0x40000000, v232
    s_waitcnt lgkmcnt(0)
    v_add_f32 v120, v120, v104
    v_add_f32 v121, v121, v105
    v_add_f32 v122, v122, v106
    v_add_f32 v123, v123, v107
    v_add_f32 v124, v124, v108
    v_add_f32 v125, v125, v109
    v_add_f32 v126, v126, v110
    v_add_f32 v127, v127, v111
    s_cbranch_vccnz L_fallback
L_fb_retb:
    v_rcp_f32 v128, v128
    s_nop 0
    v_mul_f32 v120, v128, v120
    v_mul_f32 v121, v128, v121
    v_mul_f32 v122, v128, v122
    v_mul_f32 v123, v128, v123
    v_mul_f32 v124, v128, v124
    v_mul_f32 v125, v128, v125
    v_mul_f32 v126, v128, v126
    v_mul_f32 v127, v128, v127
    v_cvt_pk_bf16_f32 v240, v120, v121
    v_cvt_pk_bf16_f32 v241, v122, v123
    v_cvt_pk_bf16_f32 v242, v124, v125
    v_cvt_pk_bf16_f32 v243, v126, v127
    s_add_u32 s3, s66, 4194304
    s_add_u32 s4, s66, 12582912
    v_add_u32 v14, v240, v242
    buffer_store_dwordx4 v[240:243], v2, s[16:19], s3 offen sc1
    s_lshl_b32 s5, s62, 4
    s_add_u32 s4, s5, 8388608
    v_add_u32_dpp v233, v14, v14 row_ror:8 row_mask:0xf bank_mask:0xf
    s_nop 1
    v_add_u32_dpp v14, v233, v233 row_ror:4 row_mask:0xf bank_mask:0xf
    s_nop 1
    v_add_u32_dpp v233, v14, v14 row_ror:2 row_mask:0xf bank_mask:0xf
    s_nop 1
    v_add_u32_dpp v14, v233, v233 row_ror:1 row_mask:0xf bank_mask:0xf
    v_sub_u32 v14, s65, v14
    buffer_store_dword v14, v4, s[16:19], s5 offen offset:320 sc1
    s_branch L_p3
L_att_g0:
    s_cmp_lt_u32 s67, 1
    s_cbranch_scc1 L_g0a_x1
    v_exp_f32 v72, v72
    v_exp_f32 v73, v73
    v_exp_f32 v74, v74
    v_exp_f32 v75, v75
    v_exp_f32 v76, v76
    v_mfma_f32_32x32x16_bf16 v[88:103], v[212:215], v[168:171], 0
    v_exp_f32 v77, v77
    v_exp_f32 v78, v78
    v_exp_f32 v79, v79
    v_exp_f32 v80, v80
    s_add_u32 m0, s63, 0
    s_add_u32 s82, s78, 0
    buffer_load_dwordx4 v17, s[28:31], s82 offen  lds
    s_add_u32 m0, s63, 8192
    s_add_u32 s82, s78, 65536
    buffer_load_dwordx4 v17, s[28:31], s82 offen  lds
    v_cvt_pk_bf16_f32 v152, v72, v73
    v_cvt_pk_bf16_f32 v153, v74, v75
    v_cvt_pk_bf16_f32 v154, v76, v77
    v_cvt_pk_bf16_f32 v155, v78, v79
    v_exp_f32 v81, v81
    v_exp_f32 v82, v82
    v_mfma_f32_32x32x16_bf16 v[120:135], v[40:43], v[152:155], v[120:135]
    v_exp_f32 v83, v83
    v_exp_f32 v84, v84
    v_exp_f32 v85, v85
    v_exp_f32 v86, v86
    v_exp_f32 v87, v87
    s_add_u32 m0, s63, 16384
    s_add_u32 s82, s78, 131072
    buffer_load_dwordx4 v17, s[28:31], s82 offen  lds
    s_add_u32 m0, s63, 24576
    s_add_u32 s82, s78, 196608
    buffer_load_dwordx4 v17, s[28:31], s82 offen  lds
    v_cvt_pk_bf16_f32 v156, v80, v81
    v_cvt_pk_bf16_f32 v157, v82, v83
    v_cvt_pk_bf16_f32 v158, v84, v85
    v_cvt_pk_bf16_f32 v159, v86, v87
    s_cmp_lt_u32 s67, 2
    s_cbranch_scc1 L_g0a_x2
    v_exp_f32 v88, v88
    v_exp_f32 v89, v89
    v_mfma_f32_32x32x16_bf16 v[120:135], v[44:47], v[156:159], v[120:135]
    v_exp_f32 v90, v90
    v_exp_f32 v91, v91
    v_exp_f32 v92, v92
    v_mfma_f32_32x32x16_bf16 v[72:87], v[216:219], v[168:171], 0
    v_exp_f32 v93, v93
    v_exp_f32 v94, v94
    v_exp_f32 v95, v95
    v_exp_f32 v96, v96
    s_add_u32 m0, s63, 65536
    s_add_u32 s82, s78, 262144
    buffer_load_dwordx4 v17, s[28:31], s82 offen  lds
    s_add_u32 m0, s63, 73728
    s_add_u32 s82, s78, 327680
    buffer_load_dwordx4 v17, s[28:31], s82 offen  lds
    v_cvt_pk_bf16_f32 v160, v88, v89
    v_cvt_pk_bf16_f32 v161, v90, v91
    v_cvt_pk_bf16_f32 v162, v92, v93
    v_cvt_pk_bf16_f32 v163, v94, v95
    v_exp_f32 v97, v97
    v_exp_f32 v98, v98
    v_mfma_f32_32x32x16_bf16 v[120:135], v[48:51], v[160:163], v[120:135]
    v_exp_f32 v99, v99
    v_exp_f32 v100, v100
    v_exp_f32 v101, v101
    v_exp_f32 v102, v102
    v_exp_f32 v103, v103
    s_add_u32 m0, s63, 81920
    s_add_u32 s82, s78, 393216
    buffer_load_dwordx4 v17, s[28:31], s82 offen  lds
    s_add_u32 m0, s63, 90112
    s_add_u32 s82, s78, 458752
    buffer_load_dwordx4 v17, s[28:31], s82 offen  lds
    v_cvt_pk_bf16_f32 v164, v96, v97
    v_cvt_pk_bf16_f32 v165, v98, v99
    v_cvt_pk_bf16_f32 v166, v100, v101
    v_cvt_pk_bf16_f32 v167, v102, v103
    s_cmp_lt_u32 s67, 3
    s_cbranch_scc1 L_g0a_x3
    v_exp_f32 v72, v72
    v_exp_f32 v73, v73
    v_mfma_f32_32x32x16_bf16 v[120:135], v[52:55], v[164:167], v[120:135]
    v_exp_f32 v74, v74
    v_exp_f32 v75, v75
    v_exp_f32 v76, v76
    v_mfma_f32_32x32x16_bf16 v[88:103], v[220:223], v[168:171], 0
    v_exp_f32 v77, v77
    v_exp_f32 v78, v78
    v_exp_f32 v79, v79
    v_exp_f32 v80, v80
    buffer_load_dwordx4 v[8:11], v247, s[8:11], s77 offen
    v_cvt_pk_bf16_f32 v152, v72, v73
    v_cvt_pk_bf16_f32 v153, v74, v75
    v_cvt_pk_bf16_f32 v154, v76, v77
    v_cvt_pk_bf16_f32 v155, v78, v79
    v_exp_f32 v81, v81
    v_exp_f32 v82, v82
    v_mfma_f32_32x32x16_bf16 v[120:135], v[56:59], v[152:155], v[120:135]
    v_exp_f32 v83, v83
    v_exp_f32 v84, v84
    v_exp_f32 v85, v85
    v_exp_f32 v86, v86
    v_exp_f32 v87, v87
    s_lshl2_add_u32 s7, s74, s70
    s_lshl_b32 s7, s7, 14
    s_and_b32 s6, s2, 7
    s_lshl_b32 s6, s6, 7
    s_add_u32 s7, s7, s6
    buffer_load_dwordx4 v[192:195], v247, s[40:43], s7 offen nt
    s_add_u32 s7, s7, 8192
    buffer_load_dwordx4 v[196:199], v247, s[40:43], s7 offen nt
    v_cvt_pk_bf16_f32 v156, v80, v81
    v_cvt_pk_bf16_f32 v157, v82, v83
    v_cvt_pk_bf16_f32 v158, v84, v85
    v_cvt_pk_bf16_f32 v159, v86, v87
    s_cmp_lt_u32 s67, 4
    s_cbranch_scc1 L_g0a_x4
    v_exp_f32 v88, v88
    v_exp_f32 v89, v89
    v_mfma_f32_32x32x16_bf16 v[120:135], v[60:63], v[156:159], v[120:135]
    v_exp_f32 v90, v90
    v_exp_f32 v91, v91
    v_exp_f32 v92, v92
    v_exp_f32 v93, v93
    v_exp_f32 v94, v94
    v_exp_f32 v95, v95
    v_exp_f32 v96, v96
    v_cvt_pk_bf16_f32 v160, v88, v89
    v_cvt_pk_bf16_f32 v161, v90, v91
    v_cvt_pk_bf16_f32 v162, v92, v93
    v_cvt_pk_bf16_f32 v163, v94, v95
    v_bfi_b32 v160, v224, 0, v160
    v_bfi_b32 v161, v225, 0, v161
    v_bfi_b32 v162, v226, 0, v162
    v_bfi_b32 v163, v227, 0, v163
    v_exp_f32 v97, v97
    v_exp_f32 v98, v98
    v_mfma_f32_32x32x16_bf16 v[120:135], v[64:67], v[160:163], v[120:135]
    v_exp_f32 v99, v99
    v_exp_f32 v100, v100
    v_exp_f32 v101, v101
    v_exp_f32 v102, v102
    v_exp_f32 v103, v103
    s_lshl_b32 s87, s74, 13
    s_lshl_b32 s6, s70, 8
    s_add_u32 s87, s87, s6
    s_add_u32 s87, s87, 6619136
    v_and_b32 v232, 7, v1
    v_lshrrev_b32 v233, 3, v1
    v_lshlrev_b32 v233, 4, v233
    v_lshl_add_u32 v254, v232, 10, v233
    s_cmp_ge_u32 s74, 22
    s_cselect_b32 s87, 1073741824, s87
    buffer_load_dwordx4 v[200:203], v254, s[16:19], s87 offen offset:0 sc1
    buffer_load_dwordx4 v[204:207], v254, s[16:19], s87 offen offset:128 sc1
    v_cvt_pk_bf16_f32 v164, v96, v97
    v_cvt_pk_bf16_f32 v165, v98, v99
    v_cvt_pk_bf16_f32 v166, v100, v101
    v_cvt_pk_bf16_f32 v167, v102, v103
    v_bfi_b32 v164, v228, 0, v164
    v_bfi_b32 v165, v229, 0, v165
    v_bfi_b32 v166, v230, 0, v166
    v_bfi_b32 v167, v231, 0, v167
    s_nop 1
    v_mfma_f32_32x32x16_bf16 v[120:135], v[68:71], v[164:167], v[120:135]
L_g0a_end:
    v_xor_b32 v234, 4096, v12
    s_mov_b32 s69, 0
L_mspina:
    ds_read_b64 v[112:113], v234 offset:24576
    ds_read_b128 v[104:107], v234
    ds_read_b128 v[108:111], v234 offset:16384
    s_waitcnt lgkmcnt(2)
    v_cmp_ne_u32 vcc, s65, v113
    s_nop 0
    s_cbranch_vccz L_moka
    s_sleep 1
    s_add_u32 s69, s69, 1
    s_cmp_gt_u32 s69, 65536
    s_cbranch_scc0 L_mspina
L_moka:
    s_nop 2
    v_add_f32 v128, v128, v112
    v_subrev_u32 v232, 0x1f800000, v128
    v_cmp_lt_u32 vcc, 0x40000000, v232
    s_waitcnt lgkmcnt(0)
    v_add_f32 v120, v120, v104
    v_add_f32 v121, v121, v105
    v_add_f32 v122, v122, v106
    v_add_f32 v123, v123, v107
    v_add_f32 v124, v124, v108
    v_add_f32 v125, v125, v109
    v_add_f32 v126, v126, v110
    v_add_f32 v127, v127, v111
    s_cbranch_vccnz L_fallback
L_fb_reta:
    v_rcp_f32 v128, v128
    s_nop 0
    v_mul_f32 v120, v128, v120
    v_mul_f32 v121, v128, v121
    v_mul_f32 v122, v128, v122
    v_mul_f32 v123, v128, v123
    v_mul_f32 v124, v128, v124
    v_mul_f32 v125, v128, v125
    v_mul_f32 v126, v128, v126
    v_mul_f32 v127, v128, v127
    v_cvt_pk_bf16_f32 v240, v120, v121
    v_cvt_pk_bf16_f32 v241, v122, v123
    v_cvt_pk_bf16_f32 v242, v124, v125
    v_cvt_pk_bf16_f32 v243, v126, v127
    s_add_u32 s3, s66, 4194304
    s_add_u32 s4, s66, 12582912
    v_add_u32 v14, v240, v242
    buffer_store_dwordx4 v[240:243], v2, s[16:19], s3 offen sc1
    s_lshl_b32 s5, s62, 4
    s_add_u32 s4, s5, 8388608
    v_add_u32_dpp v233, v14, v14 row_ror:8 row_mask:0xf bank_mask:0xf
    s_nop 1
    v_add_u32_dpp v14, v233, v233 row_ror:4 row_mask:0xf bank_mask:0xf
    s_nop 1
    v_add_u32_dpp v233, v14, v14 row_ror:2 row_mask:0xf bank_mask:0xf
    s_nop 1
    v_add_u32_dpp v14, v233, v233 row_ror:1 row_mask:0xf bank_mask:0xf
    v_sub_u32 v14, s65, v14
    buffer_store_dword v14, v4, s[16:19], s5 offen offset:256 sc1
    v_mfma_f32_32x32x16_bf16 v[72:87], v[208:211], v[172:175], 0
    v_mov_b32 v234, 162304
    ds_read_b32 v180, v234
    s_cmp_lt_u32 s67, 1
    s_cbranch_scc1 L_g0b_x1
    s_nop 7
    v_exp_f32 v72, v72
    v_exp_f32 v73, v73
    v_exp_f32 v74, v74
    v_exp_f32 v75, v75
    v_exp_f32 v76, v76
    v_mfma_f32_32x32x16_bf16 v[88:103], v[212:215], v[172:175], 0
    v_exp_f32 v77, v77
    v_exp_f32 v78, v78
    v_exp_f32 v79, v79
    v_exp_f32 v80, v80
    s_lshl2_add_u32 s3, s62, 162320
    v_mov_b32 v232, s65
    v_mov_b32 v233, s3
    s_waitcnt vmcnt(6)
    ds_write_b32 v233, v232
    v_cvt_pk_bf16_f32 v152, v72, v73
    v_cvt_pk_bf16_f32 v153, v74, v75
    v_cvt_pk_bf16_f32 v154, v76, v77
    v_cvt_pk_bf16_f32 v155, v78, v79
    v_exp_f32 v81, v81
    v_exp_f32 v82, v82
    v_mfma_f32_32x32x16_bf16 v[136:151], v[40:43], v[152:155], v[136:151]
    v_exp_f32 v83, v83
    v_exp_f32 v84, v84
    v_exp_f32 v85, v85
    v_exp_f32 v86, v86
    v_exp_f32 v87, v87
    v_cvt_pk_bf16_f32 v156, v80, v81
    v_cvt_pk_bf16_f32 v157, v82, v83
    v_cvt_pk_bf16_f32 v158, v84, v85
    v_cvt_pk_bf16_f32 v159, v86, v87
    s_cmp_lt_u32 s67, 2
    s_cbranch_scc1 L_g0b_x2
    v_exp_f32 v88, v88
    v_exp_f32 v89, v89
    v_mfma_f32_32x32x16_bf16 v[136:151], v[44:47], v[156:159], v[136:151]
    v_exp_f32 v90, v90
    v_exp_f32 v91, v91
    v_exp_f32 v92, v92
    v_mfma_f32_32x32x16_bf16 v[72:87], v[216:219], v[172:175], 0
    v_exp_f32 v93, v93
    v_exp_f32 v94, v94
    v_exp_f32 v95, v95
    v_exp_f32 v96, v96
    v_cvt_pk_bf16_f32 v160, v88, v89
    v_cvt_pk_bf16_f32 v161, v90, v91
    v_cvt_pk_bf16_f32 v162, v92, v93
    v_cvt_pk_bf16_f32 v163, v94, v95
    v_exp_f32 v97, v97
    v_exp_f32 v98, v98
    v_mfma_f32_32x32x16_bf16 v[136:151], v[48:51], v[160:163], v[136:151]
    v_exp_f32 v99, v99
    v_exp_f32 v100, v100
    v_exp_f32 v101, v101
    v_exp_f32 v102, v102
    v_exp_f32 v103, v103
    v_cvt_pk_bf16_f32 v164, v96, v97
    v_cvt_pk_bf16_f32 v165, v98, v99
    v_cvt_pk_bf16_f32 v166, v100, v101
    v_cvt_pk_bf16_f32 v167, v102, v103
    s_cmp_lt_u32 s67, 3
    s_cbranch_scc1 L_g0b_x3
    v_exp_f32 v72, v72
    v_exp_f32 v73, v73
    v_mfma_f32_32x32x16_bf16 v[136:151], v[52:55], v[164:167], v[136:151]
    v_exp_f32 v74, v74
    v_exp_f32 v75, v75
    v_exp_f32 v76, v76
    v_exp_f32 v77, v77
    v_exp_f32 v78, v78
    v_exp_f32 v79, v79
    v_exp_f32 v80, v80
    v_cvt_pk_bf16_f32 v152, v72, v73
    v_cvt_pk_bf16_f32 v153, v74, v75
    v_cvt_pk_bf16_f32 v154, v76, v77
    v_cvt_pk_bf16_f32 v155, v78, v79
    v_exp_f32 v81, v81
    v_exp_f32 v82, v82
    v_mfma_f32_32x32x16_bf16 v[136:151], v[56:59], v[152:155], v[136:151]
    v_exp_f32 v83, v83
    v_exp_f32 v84, v84
    v_exp_f32 v85, v85
    v_exp_f32 v86, v86
    v_exp_f32 v87, v87
    v_cvt_pk_bf16_f32 v156, v80, v81
    v_cvt_pk_bf16_f32 v157, v82, v83
    v_cvt_pk_bf16_f32 v158, v84, v85
    v_cvt_pk_bf16_f32 v159, v86, v87
    s_nop 1
    v_mfma_f32_32x32x16_bf16 v[136:151], v[60:63], v[156:159], v[136:151]
L_g0b_end:
    s_waitcnt lgkmcnt(0)
    v_readfirstlane_b32 s73, v180
    s_nop 5
    s_nop 3
    v_mov_b32 v145, s65
    ds_write_b128 v12, v[136:139]
    ds_write_b128 v12, v[140:143] offset:16384
    ds_write_b64 v12, v[144:145] offset:24576
    s_cmp_ge_u32 s74, 22
    s_cbranch_scc1 L_p3
    s_mov_b32 s69, 0
    s_waitcnt vmcnt(2)
    v_lshlrev_b32 v24, 16, v192
    v_and_b32 v25, s76, v192
    v_lshlrev_b32 v26, 16, v193
    v_and_b32 v27, s76, v193
    v_lshlrev_b32 v28, 16, v194
    v_and_b32 v29, s76, v194
    v_lshlrev_b32 v30, 16, v195
    v_and_b32 v31, s76, v195
    v_lshlrev_b32 v224, 16, v196
    v_and_b32 v225, s76, v196
    v_lshlrev_b32 v226, 16, v197
    v_and_b32 v227, s76, v197
    v_lshlrev_b32 v228, 16, v198
    v_and_b32 v229, s76, v198
    v_lshlrev_b32 v230, 16, v199
    v_and_b32 v231, s76, v199
L_gval:
    v_min3_u32 v232, v201, v203, v205
    v_max3_u32 v233, v201, v203, v205
    v_xor_b32 v232, s65, v232
    v_xor_b32 v233, s65, v233
    v_xor_b32 v237, s65, v207
    v_or3_b32 v232, v232, v233, v237
    v_cmp_ne_u32 vcc, 0, v232
    s_nop 0
    s_cbranch_vccnz L_gretry
L_gok:
    v_add_f32_dpp v201, v200, v200 quad_perm:[1,0,3,2] row_mask:0xf bank_mask:0xf
    v_add_f32_dpp v203, v202, v202 quad_perm:[1,0,3,2] row_mask:0xf bank_mask:0xf
    v_add_f32_dpp v205, v204, v204 quad_perm:[1,0,3,2] row_mask:0xf bank_mask:0xf
    v_add_f32_dpp v207, v206, v206 quad_perm:[1,0,3,2] row_mask:0xf bank_mask:0xf
    v_add_f32_dpp v200, v201, v201 quad_perm:[2,3,0,1] row_mask:0xf bank_mask:0xf
    v_add_f32_dpp v202, v203, v203 quad_perm:[2,3,0,1] row_mask:0xf bank_mask:0xf
    v_add_f32_dpp v204, v205, v205 quad_perm:[2,3,0,1] row_mask:0xf bank_mask:0xf
    v_add_f32_dpp v206, v207, v207 quad_perm:[2,3,0,1] row_mask:0xf bank_mask:0xf
    v_add_f32_dpp v201, v200, v200 row_half_mirror row_mask:0xf bank_mask:0xf
    v_add_f32_dpp v203, v202, v202 row_half_mirror row_mask:0xf bank_mask:0xf
    v_add_f32_dpp v205, v204, v204 row_half_mirror row_mask:0xf bank_mask:0xf
    v_add_f32_dpp v207, v206, v206 row_half_mirror row_mask:0xf bank_mask:0xf
    v_cvt_pk_bf16_f32 v200, v201, v203
    v_cvt_pk_bf16_f32 v204, v205, v207
    v_lshlrev_b32 v201, 16, v200
    v_and_b32 v203, s76, v200
    v_lshlrev_b32 v205, 16, v204
    v_and_b32 v207, s76, v204
    v_mul_f32 v200, 3216550459, v201
    v_mul_f32 v204, 3216550459, v205
    v_exp_f32 v200, v200
    v_exp_f32 v204, v204
    v_add_f32 v200, 1.0, v200
    v_add_f32 v204, 1.0, v204
    v_rcp_f32 v200, v200
    v_rcp_f32 v204, v204
    v_mul_f32 v201, v201, v200
    v_mul_f32 v205, v205, v204
    v_cvt_pk_bf16_f32 v200, v201, v205
    v_lshlrev_b32 v201, 16, v200
    v_and_b32 v205, s76, v200
    v_mul_f32 v201, v201, v203
    v_mul_f32 v205, v205, v207
    v_cvt_pk_bf16_f32 v200, v201, v205
    v_lshlrev_b32 v201, 16, v200
    v_and_b32 v205, s76, v200
    v_mul_f32 v24, v201, v24
    v_mul_f32 v25, v201, v25
    v_mul_f32 v26, v201, v26
    v_mul_f32 v27, v201, v27
    v_mul_f32 v28, v201, v28
    v_mul_f32 v29, v201, v29
    v_mul_f32 v30, v201, v30
    v_mul_f32 v31, v201, v31
    v_fmac_f32 v24, v205, v224
    v_fmac_f32 v25, v205, v225
    v_fmac_f32 v26, v205, v226
    v_fmac_f32 v27, v205, v227
    v_fmac_f32 v28, v205, v228
    v_fmac_f32 v29, v205, v229
    v_fmac_f32 v30, v205, v230
    v_fmac_f32 v31, v205, v231
    v_and_b32 v232, 7, v1
    v_lshrrev_b32 v233, 4, v1
    v_permlane32_swap_b32 v24, v28
    v_permlane32_swap_b32 v25, v29
    v_permlane32_swap_b32 v26, v30
    v_permlane32_swap_b32 v27, v31
    v_pk_add_f32 v[24:25], v[24:25], v[28:29]
    v_pk_add_f32 v[26:27], v[26:27], v[30:31]
    v_lshl_add_u32 v232, v232, 2, v233
    s_lshl_b32 s3, s70, 3
    s_add_u32 s3, s3, 157696
    v_permlane16_swap_b32 v24, v26
    v_permlane16_swap_b32 v25, v27
    v_pk_add_f32 v[24:25], v[24:25], v[26:27]
    v_lshl_add_u32 v232, v232, 6, s3
    v_mov_b32 v27, s65
    v_mov_b32 v29, s65
    v_add_f32_dpp v26, v24, v24 row_ror:8 row_mask:0xf bank_mask:0xf
    v_add_f32_dpp v28, v25, v25 row_ror:8 row_mask:0xf bank_mask:0xf
    ds_write2_b64 v232, v[26:27], v[28:29] offset0:0 offset1:4
    s_cmp_lg_u32 s62, 0
    s_cbranch_scc1 L_nod
    v_lshlrev_b32 v232, 1, v2
    v_add_u32 v232, 157696, v232
    s_and_b32 s4, s2, 7
    s_lshl3_add_u32 s88, s74, s4
    s_lshl_b32 s88, s88, 9
    s_add_u32 s88, s88, 6488064
L_yspin:
    ds_read_b128 v[24:27], v232
    ds_read_b128 v[28:31], v232 offset:16
    s_waitcnt lgkmcnt(0)
    v_min3_u32 v233, v25, v27, v29
    v_max3_u32 v237, v25, v27, v29
    v_xor_b32 v233, s65, v233
    v_xor_b32 v237, s65, v237
    v_xor_b32 v236, s65, v31
    v_or3_b32 v233, v233, v237, v236
    v_cmp_ne_u32 vcc, 0, v233
    s_nop 0
    s_cbranch_vccz L_yready
    s_add_u32 s69, s69, 1
    s_cmp_gt_u32 s69, 65536
    s_cbranch_scc0 L_yspin
L_yready:
    v_add_f32 v24, v24, v26
    v_add_f32 v28, v28, v30
    v_add_f32 v24, v24, v28
    v_lshrrev_b32 v232, 1, v2
    buffer_store_dwordx2 v[24:25], v232, s[16:19], s88 offen sc1
L_nod:
L_p3:
    s_lshl_b32 s3, s84, 16
    v_add_u32 v244, s3, v250
    v_xor_b32 v245, 32, v244
    v_xor_b32 v246, 64, v244
    v_xor_b32 v253, 96, v244
    s_mov_b32 s69, 0
    v_and_b32 v232, 7, v1
    v_lshlrev_b32 v232, 2, v232
    v_add_u32 v232, 162320, v232
L_fspinw:
    ds_read_b32 v233, v232
    s_waitcnt lgkmcnt(0)
    v_cmp_ne_u32 vcc, s65, v233
    s_nop 0
    s_cbranch_vccz L_fokw
    s_sleep 1
    s_add_u32 s69, s69, 1
    s_cmp_gt_u32 s69, 65536
    s_cbranch_scc0 L_fspinw
L_fokw:
    ds_read_b64_tr_b16 v[32:33], v244 offset:0
    v_mov_b64 v[192:193], 0
    v_mov_b64 v[194:195], 0
    v_mov_b64 v[196:197], 0
    ds_read_b64_tr_b16 v[34:35], v244 offset:1024
    v_mov_b64 v[198:199], 0
    v_mov_b64 v[200:201], 0
    v_mov_b64 v[202:203], 0
    ds_read_b64_tr_b16 v[36:37], v245 offset:0
    v_mov_b64 v[204:205], 0
    v_mov_b64 v[206:207], 0
    s_mov_b32 s75, 15
    ds_read_b64_tr_b16 v[38:39], v245 offset:1024
    s_mov_b32 s83, 0
    s_and_b32 s72, s73, 0x7ff
    s_sub_u32 s72, 2047, s72
    ds_read_b64_tr_b16 v[40:41], v246 offset:0
    s_lshr_b32 s4, s72, 3
    s_lshl3_add_u32 s5, s60, s62
    s_xor_b32 s86, s4, s5
    ds_read_b64_tr_b16 v[42:43], v246 offset:1024
    s_lshr_b32 s89, s86, 3
    s_xor_b32 s4, s62, 1
    s_or_b32 s89, s89, s4
    ds_read_b64_tr_b16 v[44:45], v253 offset:0
    s_mov_b32 s69, 0
    ds_read_b64_tr_b16 v[46:47], v253 offset:1024
    ds_read_b64_tr_b16 v[48:49], v244 offset:4096
    s_lshl_b32 s6, s62, 5
    ds_read_b64_tr_b16 v[50:51], v244 offset:5120
    s_add_u32 s6, s6, 161280
    ds_read_b64_tr_b16 v[52:53], v245 offset:4096
    v_lshrrev_b32 v234, 3, v1
    ds_read_b64_tr_b16 v[54:55], v245 offset:5120
    v_lshl_add_u32 v234, v234, 2, s6
    ds_read_b64_tr_b16 v[56:57], v246 offset:4096
    ds_read2_b32 v[224:225], v234 offset0:0 offset1:64
    ds_read_b64_tr_b16 v[58:59], v246 offset:5120
    v_lshlrev_b32 v16, 16, v8
    ds_read_b64_tr_b16 v[60:61], v253 offset:4096
    v_and_b32 v17, s76, v8
    ds_read_b64_tr_b16 v[62:63], v253 offset:5120
    v_lshlrev_b32 v18, 16, v9
    ds_read_b64_tr_b16 v[64:65], v244 offset:8192
    v_and_b32 v19, s76, v9
    ds_read_b64_tr_b16 v[66:67], v244 offset:9216
    v_lshlrev_b32 v20, 16, v10
    ds_read_b64_tr_b16 v[68:69], v245 offset:8192
    v_and_b32 v21, s76, v10
    ds_read_b64_tr_b16 v[70:71], v245 offset:9216
    v_lshlrev_b32 v22, 16, v11
    ds_read_b64_tr_b16 v[72:73], v246 offset:8192
    v_and_b32 v23, s76, v11
    ds_read_b64_tr_b16 v[74:75], v246 offset:9216
    s_waitcnt lgkmcnt(9)
    ds_read_b64_tr_b16 v[76:77], v253 offset:8192
    v_sub_f32 v24, v16, v224
    ds_read_b64_tr_b16 v[78:79], v253 offset:9216
    v_sub_f32 v25, v17, v224
    ds_read_b64_tr_b16 v[80:81], v244 offset:12288
    v_sub_f32 v26, v18, v224
    ds_read_b64_tr_b16 v[82:83], v244 offset:13312
    v_sub_f32 v27, v19, v224
    ds_read_b64_tr_b16 v[84:85], v245 offset:12288
    v_sub_f32 v28, v20, v224
    ds_read_b64_tr_b16 v[86:87], v245 offset:13312
    v_sub_f32 v29, v21, v224
    ds_read_b64_tr_b16 v[88:89], v246 offset:12288
    v_sub_f32 v30, v22, v224
    ds_read_b64_tr_b16 v[90:91], v246 offset:13312
    v_sub_f32 v31, v23, v224
    ds_read_b64_tr_b16 v[92:93], v253 offset:12288
    v_cvt_pk_bf16_f32 v236, v24, v25
    ds_read_b64_tr_b16 v[94:95], v253 offset:13312
    v_cvt_pk_bf16_f32 v237, v26, v27
    s_cmp_lg_u32 s68, 0
    s_cbranch_scc1 L_oearly
    buffer_load_dword v15, v249, s[16:19], s83 offen
    s_or_b32 s3, s83, 0
    buffer_load_dwordx4 v[160:163], v248, s[16:19], s3 offen
    buffer_load_dwordx4 v[164:167], v248, s[16:19], s3 offen offset:2048
    s_or_b32 s3, s83, 8192
    buffer_load_dwordx4 v[168:171], v248, s[16:19], s3 offen
    buffer_load_dwordx4 v[172:175], v248, s[16:19], s3 offen offset:2048
    s_or_b32 s3, s83, 16384
    buffer_load_dwordx4 v[176:179], v248, s[16:19], s3 offen
    buffer_load_dwordx4 v[180:183], v248, s[16:19], s3 offen offset:2048
    s_or_b32 s3, s83, 24576
    buffer_load_dwordx4 v[184:187], v248, s[16:19], s3 offen
    buffer_load_dwordx4 v[188:191], v248, s[16:19], s3 offen offset:2048
L_oearly:
    ds_read_b64_tr_b16 v[96:97], v244 offset:16384
    v_cvt_pk_bf16_f32 v238, v28, v29
    ds_read_b64_tr_b16 v[98:99], v244 offset:17408
    v_cvt_pk_bf16_f32 v239, v30, v31
    ds_read_b64_tr_b16 v[100:101], v245 offset:16384
    v_lshlrev_b32 v24, 16, v236
    ds_read_b64_tr_b16 v[102:103], v245 offset:17408
    v_and_b32 v25, s76, v236
    ds_read_b64_tr_b16 v[104:105], v246 offset:16384
    v_lshlrev_b32 v26, 16, v237
    ds_read_b64_tr_b16 v[106:107], v246 offset:17408
    v_and_b32 v27, s76, v237
    ds_read_b64_tr_b16 v[108:109], v253 offset:16384
    v_lshlrev_b32 v28, 16, v238
    ds_read_b64_tr_b16 v[110:111], v253 offset:17408
    v_and_b32 v29, s76, v238
    ds_read_b64_tr_b16 v[112:113], v244 offset:20480
    v_lshlrev_b32 v30, 16, v239
    ds_read_b64_tr_b16 v[114:115], v244 offset:21504
    v_and_b32 v31, s76, v239
    ds_read_b64_tr_b16 v[116:117], v245 offset:20480
    v_mul_f32 v24, v225, v24
    ds_read_b64_tr_b16 v[118:119], v245 offset:21504
    v_mul_f32 v25, v225, v25
    ds_read_b64_tr_b16 v[120:121], v246 offset:20480
    v_mul_f32 v26, v225, v26
    ds_read_b64_tr_b16 v[122:123], v246 offset:21504
    v_mul_f32 v27, v225, v27
    ds_read_b64_tr_b16 v[124:125], v253 offset:20480
    v_mul_f32 v28, v225, v28
    ds_read_b64_tr_b16 v[126:127], v253 offset:21504
    v_mul_f32 v29, v225, v29
    ds_read_b64_tr_b16 v[128:129], v244 offset:24576
    v_mul_f32 v30, v225, v30
    ds_read_b64_tr_b16 v[130:131], v244 offset:25600
    v_mul_f32 v31, v225, v31
    ds_read_b64_tr_b16 v[132:133], v245 offset:24576
    v_cvt_pk_bf16_f32 v236, v24, v25
    ds_read_b64_tr_b16 v[134:135], v245 offset:25600
    v_cvt_pk_bf16_f32 v237, v26, v27
    ds_read_b64_tr_b16 v[136:137], v246 offset:24576
    v_cvt_pk_bf16_f32 v238, v28, v29
    ds_read_b64_tr_b16 v[138:139], v246 offset:25600
    v_cvt_pk_bf16_f32 v239, v30, v31
    ds_read_b64_tr_b16 v[140:141], v253 offset:24576
    v_lshlrev_b32 v24, 16, v236
    ds_read_b64_tr_b16 v[142:143], v253 offset:25600
    v_and_b32 v25, s76, v236
    ds_read_b64_tr_b16 v[144:145], v244 offset:28672
    v_lshlrev_b32 v26, 16, v237
    ds_read_b64_tr_b16 v[146:147], v244 offset:29696
    v_and_b32 v27, s76, v237
    ds_read_b64_tr_b16 v[148:149], v245 offset:28672
    v_lshlrev_b32 v28, 16, v238
    ds_read_b64_tr_b16 v[150:151], v245 offset:29696
    v_and_b32 v29, s76, v238
    ds_read_b64_tr_b16 v[152:153], v246 offset:28672
    v_lshlrev_b32 v30, 16, v239
    ds_read_b64_tr_b16 v[154:155], v246 offset:29696
    v_and_b32 v31, s76, v239
    ds_read_b64_tr_b16 v[156:157], v253 offset:28672
    v_add_f32 v16, v16, v24
    ds_read_b64_tr_b16 v[158:159], v253 offset:29696
    v_add_f32 v17, v17, v25
    v_add_f32 v18, v18, v26
    v_add_f32 v19, v19, v27
    v_add_f32 v20, v20, v28
    v_add_f32 v21, v21, v29
    v_add_f32 v22, v22, v30
    v_add_f32 v23, v23, v31
    s_waitcnt vmcnt(0)
    s_cmp_eq_u32 s68, 0
    s_cbranch_scc1 L_oskip
    buffer_load_dword v15, v249, s[16:19], s83 offen
    s_or_b32 s3, s83, 0
    buffer_load_dwordx4 v[160:163], v248, s[16:19], s3 offen
    buffer_load_dwordx4 v[164:167], v248, s[16:19], s3 offen offset:2048
    s_or_b32 s3, s83, 8192
    buffer_load_dwordx4 v[168:171], v248, s[16:19], s3 offen
    buffer_load_dwordx4 v[172:175], v248, s[16:19], s3 offen offset:2048
    s_or_b32 s3, s83, 16384
    buffer_load_dwordx4 v[176:179], v248, s[16:19], s3 offen
    buffer_load_dwordx4 v[180:183], v248, s[16:19], s3 offen offset:2048
    s_or_b32 s3, s83, 24576
    buffer_load_dwordx4 v[184:187], v248, s[16:19], s3 offen
    buffer_load_dwordx4 v[188:191], v248, s[16:19], s3 offen offset:2048
L_oskip:
    s_waitcnt vmcnt(6)
    v_add3_u32 v232, v160, v162, v164
    v_add_u32 v232, v232, v166
    s_nop 1
    v_add_u32_dpp v232, v15, v232 quad_perm:[0,1,2,3] row_mask:0xf bank_mask:1
    s_nop 1
    v_add_u32_dpp v233, v232, v232 row_ror:8 row_mask:0xf bank_mask:0xf
    s_nop 1
    v_add_u32_dpp v232, v233, v233 row_ror:4 row_mask:0xf bank_mask:0xf
    s_nop 1
    v_add_u32_dpp v233, v232, v232 row_ror:2 row_mask:0xf bank_mask:0xf
    s_nop 1
    v_add_u32_dpp v232, v233, v233 row_ror:1 row_mask:0xf bank_mask:0xf
    v_cmp_ne_u32 vcc, s79, v232
    s_waitcnt lgkmcnt(15)
    s_cbranch_vccnz L_ofirst0
    v_mfma_f32_16x16x32_bf16 v[192:195], v[32:35], v[160:163], v[192:195]
    v_mfma_f32_16x16x32_bf16 v[196:199], v[36:39], v[160:163], v[196:199]
    v_mfma_f32_16x16x32_bf16 v[200:203], v[40:43], v[160:163], v[200:203]
    v_mfma_f32_16x16x32_bf16 v[204:207], v[44:47], v[160:163], v[204:207]
    v_mfma_f32_16x16x32_bf16 v[192:195], v[48:51], v[164:167], v[192:195]
    v_mfma_f32_16x16x32_bf16 v[196:199], v[52:55], v[164:167], v[196:199]
    v_mfma_f32_16x16x32_bf16 v[200:203], v[56:59], v[164:167], v[200:203]
    v_mfma_f32_16x16x32_bf16 v[204:207], v[60:63], v[164:167], v[204:207]
    s_bitset0_b32 s75, 0
L_ofirst0:
    s_waitcnt vmcnt(4)
    v_add3_u32 v232, v168, v170, v172
    v_add_u32 v232, v232, v174
    s_nop 1
    v_add_u32_dpp v232, v15, v232 quad_perm:[0,1,2,3] row_mask:0xf bank_mask:2
    s_nop 1
    v_add_u32_dpp v233, v232, v232 row_ror:8 row_mask:0xf bank_mask:0xf
    s_nop 1
    v_add_u32_dpp v232, v233, v233 row_ror:4 row_mask:0xf bank_mask:0xf
    s_nop 1
    v_add_u32_dpp v233, v232, v232 row_ror:2 row_mask:0xf bank_mask:0xf
    s_nop 1
    v_add_u32_dpp v232, v233, v233 row_ror:1 row_mask:0xf bank_mask:0xf
    v_cmp_ne_u32 vcc, s79, v232
    s_nop 0
    s_cbranch_vccnz L_ofirst1
    v_mfma_f32_16x16x32_bf16 v[192:195], v[64:67], v[168:171], v[192:195]
    v_mfma_f32_16x16x32_bf16 v[196:199], v[68:71], v[168:171], v[196:199]
    v_mfma_f32_16x16x32_bf16 v[200:203], v[72:75], v[168:171], v[200:203]
    v_mfma_f32_16x16x32_bf16 v[204:207], v[76:79], v[168:171], v[204:207]
    v_mfma_f32_16x16x32_bf16 v[192:195], v[80:83], v[172:175], v[192:195]
    v_mfma_f32_16x16x32_bf16 v[196:199], v[84:87], v[172:175], v[196:199]
    v_mfma_f32_16x16x32_bf16 v[200:203], v[88:91], v[172:175], v[200:203]
    v_mfma_f32_16x16x32_bf16 v[204:207], v[92:95], v[172:175], v[204:207]
    s_bitset0_b32 s75, 1
L_ofirst1:
    s_waitcnt vmcnt(2)
    v_add3_u32 v232, v176, v178, v180
    v_add_u32 v232, v232, v182
    s_nop 1
    v_add_u32_dpp v232, v15, v232 quad_perm:[0,1,2,3] row_mask:0xf bank_mask:4
    s_nop 1
    v_add_u32_dpp v233, v232, v232 row_ror:8 row_mask:0xf bank_mask:0xf
    s_nop 1
    v_add_u32_dpp v232, v233, v233 row_ror:4 row_mask:0xf bank_mask:0xf
    s_nop 1
    v_add_u32_dpp v233, v232, v232 row_ror:2 row_mask:0xf bank_mask:0xf
    s_nop 1
    v_add_u32_dpp v232, v233, v233 row_ror:1 row_mask:0xf bank_mask:0xf
    v_cmp_ne_u32 vcc, s79, v232
    s_nop 0
    s_cbranch_vccnz L_ofirst2
    v_mfma_f32_16x16x32_bf16 v[192:195], v[96:99], v[176:179], v[192:195]
    v_mfma_f32_16x16x32_bf16 v[196:199], v[100:103], v[176:179], v[196:199]
    v_mfma_f32_16x16x32_bf16 v[200:203], v[104:107], v[176:179], v[200:203]
    v_mfma_f32_16x16x32_bf16 v[204:207], v[108:111], v[176:179], v[204:207]
    v_mfma_f32_16x16x32_bf16 v[192:195], v[112:115], v[180:183], v[192:195]
    v_mfma_f32_16x16x32_bf16 v[196:199], v[116:119], v[180:183], v[196:199]
    v_mfma_f32_16x16x32_bf16 v[200:203], v[120:123], v[180:183], v[200:203]
    v_mfma_f32_16x16x32_bf16 v[204:207], v[124:127], v[180:183], v[204:207]
    s_bitset0_b32 s75, 2
L_ofirst2:
    s_waitcnt vmcnt(0)
    v_add3_u32 v232, v184, v186, v188
    v_add_u32 v232, v232, v190
    s_nop 1
    v_add_u32_dpp v232, v15, v232 quad_perm:[0,1,2,3] row_mask:0xf bank_mask:8
    s_nop 1
    v_add_u32_dpp v233, v232, v232 row_ror:8 row_mask:0xf bank_mask:0xf
    s_nop 1
    v_add_u32_dpp v232, v233, v233 row_ror:4 row_mask:0xf bank_mask:0xf
    s_nop 1
    v_add_u32_dpp v233, v232, v232 row_ror:2 row_mask:0xf bank_mask:0xf
    s_nop 1
    v_add_u32_dpp v232, v233, v233 row_ror:1 row_mask:0xf bank_mask:0xf
    v_cmp_ne_u32 vcc, s79, v232
    s_waitcnt lgkmcnt(0)
    s_cbranch_vccnz L_ofirst3
    v_mfma_f32_16x16x32_bf16 v[192:195], v[128:131], v[184:187], v[192:195]
    v_mfma_f32_16x16x32_bf16 v[196:199], v[132:135], v[184:187], v[196:199]
    v_mfma_f32_16x16x32_bf16 v[200:203], v[136:139], v[184:187], v[200:203]
    v_mfma_f32_16x16x32_bf16 v[204:207], v[140:143], v[184:187], v[204:207]
    v_mfma_f32_16x16x32_bf16 v[192:195], v[144:147], v[188:191], v[192:195]
    v_mfma_f32_16x16x32_bf16 v[196:199], v[148:151], v[188:191], v[196:199]
    v_mfma_f32_16x16x32_bf16 v[200:203], v[152:155], v[188:191], v[200:203]
    v_mfma_f32_16x16x32_bf16 v[204:207], v[156:159], v[188:191], v[204:207]
    s_bitset0_b32 s75, 3
L_ofirst3:
    v_xor_b32 v234, 64, v251
    v_xor_b32 v235, 16, v252
    s_cmp_lg_u32 s75, 0
    s_cbranch_scc1 L_oretry
L_odone:
    ds_write_b128 v251, v[192:195]
    ds_write_b128 v234, v[196:199]
    ds_write_b128 v251, v[200:203] offset:128
    ds_write_b128 v234, v[204:207] offset:128
    s_mov_b32 s75, 0
    s_cmp_lg_u32 s89, 0
    s_cbranch_scc1 L_noyld
    v_lshrrev_b32 v232, 5, v1
    v_and_b32 v233, 0x1f0, v2
    v_lshl_add_u32 v233, v232, 12, v233
    s_lshl_b32 s87, s61, 9
    s_add_u32 s87, s87, 6488064
    s_mov_b32 s69, 0
L_yretry:
    s_add_u32 s4, s87, 0
    buffer_load_dwordx4 v[64:67], v233, s[16:19], s4 offen sc1
    s_add_u32 s4, s87, 8192
    buffer_load_dwordx4 v[68:71], v233, s[16:19], s4 offen sc1
    s_add_u32 s4, s87, 16384
    buffer_load_dwordx4 v[72:75], v233, s[16:19], s4 offen sc1
    s_add_u32 s4, s87, 24576
    buffer_load_dwordx4 v[76:79], v233, s[16:19], s4 offen sc1
    s_add_u32 s4, s87, 32768
    buffer_load_dwordx4 v[80:83], v233, s[16:19], s4 offen sc1
    s_add_u32 s4, s87, 40960
    buffer_load_dwordx4 v[84:87], v233, s[16:19], s4 offen sc1
    s_add_u32 s4, s87, 49152
    buffer_load_dwordx4 v[88:91], v233, s[16:19], s4 offen sc1
    s_add_u32 s4, s87, 57344
    buffer_load_dwordx4 v[92:95], v233, s[16:19], s4 offen sc1
    s_add_u32 s4, s87, 65536
    buffer_load_dwordx4 v[96:99], v233, s[16:19], s4 offen sc1
    s_add_u32 s4, s87, 73728
    buffer_load_dwordx4 v[100:103], v233, s[16:19], s4 offen sc1
    s_add_u32 s4, s87, 81920
    buffer_load_dwordx4 v[104:107], v233, s[16:19], s4 offen sc1
    s_and_b32 s5, s73, 0x7fff0000
    s_andn2_b32 s7, s76, s73
    s_bitcmp1_b32 s73, 31
    s_cselect_b32 s5, s5, s7
    v_mov_b32 v108, s5
    v_mul_f32 v108, 3216550459, v108
    v_exp_f32 v108, v108
    s_nop 0
    v_add_f32 v108, 1.0, v108
    v_rcp_f32 v108, v108
    s_nop 0
    v_cvt_pk_bf16_f32 v108, v108, v108
    v_and_b32 v108, s76, v108
    s_waitcnt vmcnt(0)
    v_min_u32 v232, v65, v67
    v_max_u32 v234, v65, v67
    v_min3_u32 v232, v232, v69, v71
    v_max3_u32 v234, v234, v69, v71
    v_min3_u32 v232, v232, v73, v75
    v_max3_u32 v234, v234, v73, v75
    v_min3_u32 v232, v232, v77, v79
    v_max3_u32 v234, v234, v77, v79
    v_min3_u32 v232, v232, v81, v83
    v_max3_u32 v234, v234, v81, v83
    v_min3_u32 v232, v232, v85, v87
    v_max3_u32 v234, v234, v85, v87
    v_min3_u32 v232, v232, v89, v91
    v_max3_u32 v234, v234, v89, v91
    v_min3_u32 v232, v232, v93, v95
    v_max3_u32 v234, v234, v93, v95
    v_min3_u32 v232, v232, v97, v99
    v_max3_u32 v234, v234, v97, v99
    v_min3_u32 v232, v232, v101, v103
    v_max3_u32 v234, v234, v101, v103
    v_min3_u32 v232, v232, v105, v107
    v_max3_u32 v234, v234, v105, v107
    v_cmp_ne_u32 vcc, s65, v232
    v_cmp_ne_u32 s[98:99], s65, v234
    s_nop 0
    s_or_b64 vcc, vcc, s[98:99]
    s_cbranch_scc1 L_ybad
L_yok:
    v_add_f32 v64, v64, v68
    v_add_f32 v66, v66, v70
    v_add_f32 v64, v64, v72
    v_add_f32 v66, v66, v74
    v_add_f32 v64, v64, v76
    v_add_f32 v66, v66, v78
    v_add_f32 v64, v64, v80
    v_add_f32 v66, v66, v82
    v_add_f32 v64, v64, v84
    v_add_f32 v66, v66, v86
    v_add_f32 v64, v64, v88
    v_add_f32 v66, v66, v90
    v_add_f32 v64, v64, v92
    v_add_f32 v66, v66, v94
    v_add_f32 v64, v64, v96
    v_add_f32 v66, v66, v98
    v_add_f32 v64, v64, v100
    v_add_f32 v66, v66, v102
    v_add_f32 v64, v64, v104
    v_add_f32 v66, v66, v106
    v_and_b32 v232, 31, v1
    v_lshrrev_b32 v234, 5, v1
    v_permlane32_swap_b32 v64, v66
    v_add_f32 v64, v64, v66
    v_lshl_add_u32 v232, v232, 1, v234
    v_cvt_pk_bf16_f32 v64, v64, v64
    v_and_b32 v64, s76, v64
    v_lshlrev_b32 v232, 2, v232
    v_mul_f32 v64, v64, v108
    v_add_u32 v232, 156672, v232
    v_cvt_pk_bf16_f32 v64, v64, v64
    v_and_b32 v64, s76, v64
    ds_write_b32 v232, v64
    ds_write_b32 v232, v65 offset:256
    s_cmp_eq_u32 s75, 2
    s_cbranch_scc1 L_ylate_ret
    s_mov_b32 s75, 0
L_noyld:
    s_waitcnt lgkmcnt(0)
    s_barrier
    ds_read_b128 v[32:35], v252
    ds_read_b128 v[36:39], v235
    ds_read_b128 v[40:43], v252 offset:16384
    ds_read_b128 v[44:47], v235 offset:16384
    s_waitcnt lgkmcnt(2)
    v_pk_add_f32 v[16:17], v[16:17], v[32:33]
    v_pk_add_f32 v[18:19], v[18:19], v[34:35]
    v_pk_add_f32 v[20:21], v[20:21], v[36:37]
    v_pk_add_f32 v[22:23], v[22:23], v[38:39]
    s_waitcnt lgkmcnt(0)
    v_pk_add_f32 v[16:17], v[16:17], v[40:41]
    v_pk_add_f32 v[18:19], v[18:19], v[42:43]
    v_pk_add_f32 v[20:21], v[20:21], v[44:45]
    v_pk_add_f32 v[22:23], v[22:23], v[46:47]
    v_cvt_pk_bf16_f32 v32, v16, v17
    v_cvt_pk_bf16_f32 v33, v18, v19
    v_cvt_pk_bf16_f32 v34, v20, v21
    v_cvt_pk_bf16_f32 v35, v22, v23
    s_cmp_eq_u32 s86, 0
    s_cselect_b32 s3, 1073741824, s77
    buffer_store_dwordx4 v[32:35], v247, s[44:47], s3 offen sc1
    s_lshl_b32 s75, s75, 1
    s_cbranch_scc1 L_yretry
L_ylate_ret:
    s_cmp_eq_u32 s86, 0
    s_cbranch_scc1 L_owner
L_owner_ret:
    s_endpgm
L_exit:
    s_endpgm
L_g1:
    v_mov_b64 v[176:177], v[28:29]
    v_mov_b64 v[178:179], v[28:29]
    v_mov_b64 v[180:181], v[28:29]
    v_mov_b64 v[182:183], v[28:29]
    v_mov_b64 v[192:193], v[28:29]
    v_mov_b64 v[194:195], v[28:29]
    v_mov_b64 v[196:197], v[28:29]
    v_mov_b64 v[198:199], v[28:29]
    s_waitcnt vmcnt(5) lgkmcnt(0)
    s_barrier
    ds_read_b128 v[32:35], v10 offset:0
    ds_read_b128 v[40:43], v12 offset:0
    s_mov_b64 exec, s[96:97]
    ds_read_b128 v[176:179], v16 offset:0
    ds_read_b128 v[180:183], v16 offset:64
    s_mov_b64 exec, -1
    ds_read_b128 v[36:39], v11 offset:0
    ds_read_b128 v[44:47], v13 offset:0
    s_barrier
    s_xor_b32 s82, s64, 512
    s_add_u32 m0, s63, 98304
    s_mul_i32 s56, s82, 1536
    buffer_load_dwordx4 v8, s[8:11], s82 offen  lds
    s_add_u32 m0, s63, 32768
    s_nop 0
    buffer_load_dwordx4 v9, s[12:15], s56 offen  lds
    buffer_load_dword v17, v3, s[20:23], 0 offen sc1
    s_waitcnt lgkmcnt(0)
    ds_read_b128 v[48:51], v10 offset:8192
    ds_read_b128 v[56:59], v12 offset:8192
    s_mov_b64 exec, s[96:97]
    ds_read_b128 v[192:195], v16 offset:128
    ds_read_b128 v[196:199], v16 offset:192
    s_mov_b64 exec, -1
    ds_read_b128 v[52:55], v11 offset:8192
    ds_read_b128 v[60:63], v13 offset:8192
    v_mfma_f32_16x16x32_bf16 v[24:27], v[176:179], v[32:35], 0
    v_mfma_f32_4x4x4_16b_bf16 v[160:163], v[32:33], v[32:33], 0
    v_mfma_f32_4x4x4_16b_bf16 v[164:167], v[34:35], v[34:35], 0
    v_mfma_f32_16x16x32_bf16 v[24:27], v[180:183], v[40:43], v[24:27]
    v_mfma_f32_4x4x4_16b_bf16 v[160:163], v[40:41], v[40:41], v[160:163]
    v_mfma_f32_4x4x4_16b_bf16 v[164:167], v[42:43], v[42:43], v[164:167]
    s_waitcnt vmcnt(5)
    s_barrier
    s_xor_b32 s82, s64, 640
    s_add_u32 m0, s63, 106496
    s_mul_i32 s57, s82, 1536
    buffer_load_dwordx4 v8, s[8:11], s82 offen  lds
    s_add_u32 m0, s63, 40960
    s_nop 0
    buffer_load_dwordx4 v9, s[12:15], s57 offen  lds
    s_waitcnt lgkmcnt(0)
    ds_read_b128 v[64:67], v10 offset:16384
    ds_read_b128 v[72:75], v12 offset:16384
    s_mov_b64 exec, s[96:97]
    ds_read_b128 v[176:179], v16 offset:256
    ds_read_b128 v[180:183], v16 offset:320
    s_mov_b64 exec, -1
    ds_read_b128 v[68:71], v11 offset:16384
    ds_read_b128 v[76:79], v13 offset:16384
    v_mfma_f32_16x16x32_bf16 v[24:27], v[192:195], v[48:51], v[24:27]
    v_mfma_f32_4x4x4_16b_bf16 v[160:163], v[48:49], v[48:49], v[160:163]
    v_mfma_f32_4x4x4_16b_bf16 v[164:167], v[50:51], v[50:51], v[164:167]
    v_mfma_f32_16x16x32_bf16 v[24:27], v[196:199], v[56:59], v[24:27]
    v_mfma_f32_4x4x4_16b_bf16 v[160:163], v[56:57], v[56:57], v[160:163]
    v_mfma_f32_4x4x4_16b_bf16 v[164:167], v[58:59], v[58:59], v[164:167]
    s_waitcnt vmcnt(5)
    s_barrier
    s_xor_b32 s82, s64, 768
    s_add_u32 m0, s63, 114688
    s_mul_i32 s58, s82, 1536
    buffer_load_dwordx4 v8, s[8:11], s82 offen  lds
    s_add_u32 m0, s63, 49152
    s_nop 0
    buffer_load_dwordx4 v9, s[12:15], s58 offen  lds
    s_waitcnt lgkmcnt(0)
    ds_read_b128 v[80:83], v10 offset:24576
    ds_read_b128 v[88:91], v12 offset:24576
    s_mov_b64 exec, s[96:97]
    ds_read_b128 v[192:195], v16 offset:384
    ds_read_b128 v[196:199], v16 offset:448
    s_mov_b64 exec, -1
    ds_read_b128 v[84:87], v11 offset:24576
    ds_read_b128 v[92:95], v13 offset:24576
    v_mfma_f32_16x16x32_bf16 v[24:27], v[176:179], v[64:67], v[24:27]
    v_mfma_f32_4x4x4_16b_bf16 v[160:163], v[64:65], v[64:65], v[160:163]
    v_mfma_f32_4x4x4_16b_bf16 v[164:167], v[66:67], v[66:67], v[164:167]
    v_mfma_f32_16x16x32_bf16 v[24:27], v[180:183], v[72:75], v[24:27]
    v_mfma_f32_4x4x4_16b_bf16 v[160:163], v[72:73], v[72:73], v[160:163]
    v_mfma_f32_4x4x4_16b_bf16 v[164:167], v[74:75], v[74:75], v[164:167]
    s_waitcnt vmcnt(5)
    s_barrier
    s_xor_b32 s82, s64, 896
    s_add_u32 m0, s63, 122880
    s_mul_i32 s59, s82, 1536
    buffer_load_dwordx4 v8, s[8:11], s82 offen  lds
    s_add_u32 m0, s63, 57344
    s_nop 0
    buffer_load_dwordx4 v9, s[12:15], s59 offen  lds
    s_waitcnt lgkmcnt(0)
    ds_read_b128 v[96:99], v10 offset:32768
    ds_read_b128 v[104:107], v12 offset:32768
    s_mov_b64 exec, s[96:97]
    ds_read_b128 v[176:179], v16 offset:512
    ds_read_b128 v[180:183], v16 offset:576
    s_mov_b64 exec, -1
    ds_read_b128 v[100:103], v11 offset:32768
    ds_read_b128 v[108:111], v13 offset:32768
    v_mfma_f32_16x16x32_bf16 v[24:27], v[192:195], v[80:83], v[24:27]
    v_mfma_f32_4x4x4_16b_bf16 v[160:163], v[80:81], v[80:81], v[160:163]
    v_mfma_f32_4x4x4_16b_bf16 v[164:167], v[82:83], v[82:83], v[164:167]
    v_mfma_f32_16x16x32_bf16 v[24:27], v[196:199], v[88:91], v[24:27]
    v_mfma_f32_4x4x4_16b_bf16 v[160:163], v[88:89], v[88:89], v[160:163]
    v_mfma_f32_4x4x4_16b_bf16 v[164:167], v[90:91], v[90:91], v[164:167]
    s_waitcnt vmcnt(4)
    s_barrier
    v_add_u32 v9, 1024, v9
    s_add_u32 m0, s63, 0
    s_nop 0
    buffer_load_dwordx4 v9, s[12:15], s52 offen  lds
    s_add_u32 m0, s63, 8192
    s_nop 0
    buffer_load_dwordx4 v9, s[12:15], s53 offen  lds
    s_waitcnt lgkmcnt(0)
    ds_read_b128 v[112:115], v10 offset:40960
    ds_read_b128 v[120:123], v12 offset:40960
    s_mov_b64 exec, s[96:97]
    ds_read_b128 v[192:195], v16 offset:640
    ds_read_b128 v[196:199], v16 offset:704
    s_mov_b64 exec, -1
    ds_read_b128 v[116:119], v11 offset:40960
    ds_read_b128 v[124:127], v13 offset:40960
    v_mfma_f32_16x16x32_bf16 v[24:27], v[176:179], v[96:99], v[24:27]
    v_mfma_f32_4x4x4_16b_bf16 v[160:163], v[96:97], v[96:97], v[160:163]
    v_mfma_f32_4x4x4_16b_bf16 v[164:167], v[98:99], v[98:99], v[164:167]
    v_mfma_f32_16x16x32_bf16 v[24:27], v[180:183], v[104:107], v[24:27]
    v_mfma_f32_4x4x4_16b_bf16 v[160:163], v[104:105], v[104:105], v[160:163]
    v_mfma_f32_4x4x4_16b_bf16 v[164:167], v[106:107], v[106:107], v[164:167]
    s_waitcnt vmcnt(4)
    s_barrier
    s_add_u32 m0, s63, 16384
    s_nop 0
    buffer_load_dwordx4 v9, s[12:15], s54 offen  lds
    s_add_u32 m0, s63, 24576
    s_nop 0
    buffer_load_dwordx4 v9, s[12:15], s55 offen  lds
    s_waitcnt lgkmcnt(0)
    ds_read_b128 v[128:131], v10 offset:49152
    ds_read_b128 v[136:139], v12 offset:49152
    s_mov_b64 exec, s[96:97]
    ds_read_b128 v[176:179], v16 offset:768
    ds_read_b128 v[180:183], v16 offset:832
    s_mov_b64 exec, -1
    ds_read_b128 v[132:135], v11 offset:49152
    ds_read_b128 v[140:143], v13 offset:49152
    v_mfma_f32_16x16x32_bf16 v[24:27], v[192:195], v[112:115], v[24:27]
    v_mfma_f32_4x4x4_16b_bf16 v[160:163], v[112:113], v[112:113], v[160:163]
    v_mfma_f32_4x4x4_16b_bf16 v[164:167], v[114:115], v[114:115], v[164:167]
    v_mfma_f32_16x16x32_bf16 v[24:27], v[196:199], v[120:123], v[24:27]
    v_mfma_f32_4x4x4_16b_bf16 v[160:163], v[120:121], v[120:121], v[160:163]
    v_mfma_f32_4x4x4_16b_bf16 v[164:167], v[122:123], v[122:123], v[164:167]
    s_waitcnt vmcnt(4)
    s_barrier
    s_add_u32 m0, s63, 32768
    s_nop 0
    buffer_load_dwordx4 v9, s[12:15], s56 offen  lds
    s_add_u32 m0, s63, 40960
    s_nop 0
    buffer_load_dwordx4 v9, s[12:15], s57 offen  lds
    s_cmp_lg_u32 s62, 7
    s_cbranch_scc1 L_t2_0
    s_lshl_b32 s83, s60, 7
    s_add_u32 s83, s83, s61
    s_lshl_b32 s83, s83, 7
    v_and_b32 v255, 15, v1
    v_lshlrev_b32 v255, 10, v255
    buffer_load_dword v255, v255, s[28:31], s83 offen
    s_branch L_t2_done
L_t2_0:
    buffer_load_dword v255, v3, s[20:23], 0 offen offset:1024
L_t2_done:
    s_waitcnt lgkmcnt(0)
    ds_read_b128 v[144:147], v10 offset:57344
    ds_read_b128 v[152:155], v12 offset:57344
    s_mov_b64 exec, s[96:97]
    ds_read_b128 v[192:195], v16 offset:896
    ds_read_b128 v[196:199], v16 offset:960
    s_mov_b64 exec, -1
    ds_read_b128 v[148:151], v11 offset:57344
    ds_read_b128 v[156:159], v13 offset:57344
    v_mfma_f32_16x16x32_bf16 v[24:27], v[176:179], v[128:131], v[24:27]
    v_mfma_f32_4x4x4_16b_bf16 v[160:163], v[128:129], v[128:129], v[160:163]
    v_mfma_f32_4x4x4_16b_bf16 v[164:167], v[130:131], v[130:131], v[164:167]
    v_mfma_f32_16x16x32_bf16 v[24:27], v[180:183], v[136:139], v[24:27]
    v_mfma_f32_4x4x4_16b_bf16 v[160:163], v[136:137], v[136:137], v[160:163]
    v_mfma_f32_4x4x4_16b_bf16 v[164:167], v[138:139], v[138:139], v[164:167]
    v_mul_u32_u24 v232, 48, v0
    v_lshrrev_b32 v233, 5, v1
    v_lshl_add_u32 v232, v233, 2, v232
    s_lshl_b32 s3, s85, 3
    s_add_u32 s3, s3, 157696
    v_add_u32 v233, s3, v232
    s_lshl_b32 s3, s85, 2
    s_add_u32 s3, s3, 157712
    v_add_u32 v232, s3, v232
    s_waitcnt lgkmcnt(0)
    v_mfma_f32_16x16x32_bf16 v[24:27], v[192:195], v[144:147], v[24:27]
    v_mfma_f32_4x4x4_16b_bf16 v[160:163], v[144:145], v[144:145], v[160:163]
    v_mfma_f32_4x4x4_16b_bf16 v[164:167], v[146:147], v[146:147], v[164:167]
    v_mfma_f32_16x16x32_bf16 v[24:27], v[196:199], v[152:155], v[24:27]
    v_mfma_f32_4x4x4_16b_bf16 v[160:163], v[152:153], v[152:153], v[160:163]
    v_mfma_f32_4x4x4_16b_bf16 v[164:167], v[154:155], v[154:155], v[164:167]
    s_mov_b32 s3, 0x22222222
    s_nop 3
    v_add_f32 v18, v160, v164
    s_mov_b32 exec_lo, s3
    s_mov_b32 exec_hi, s3
    v_add_f32 v18, v161, v165
    s_lshl_b64 exec, exec, 1
    v_add_f32 v18, v162, v166
    s_lshl_b64 exec, exec, 1
    v_add_f32 v18, v163, v167
    s_mov_b64 exec, 0xffff
    ds_write2_b32 v232, v24, v26 offset0:0 offset1:2
    ds_write2_b32 v232, v25, v27 offset0:192 offset1:194
    s_mov_b64 exec, -1
    ds_write_b32 v233, v18
    s_setprio 1
    s_and_b32 s86, s2, 7
    s_waitcnt vmcnt(5) lgkmcnt(0)
    s_barrier
    s_add_u32 m0, s63, 49152
    s_nop 0
    buffer_load_dwordx4 v9, s[12:15], s58 offen  lds
    s_add_u32 m0, s63, 57344
    s_nop 0
    buffer_load_dwordx4 v9, s[12:15], s59 offen  lds
    ds_read_b64_tr_b16 v[176:177], v14 offset:0
    ds_read_b64_tr_b16 v[178:179], v14 offset:512
    ds_read_b64_tr_b16 v[180:181], v15 offset:0
    ds_read_b64_tr_b16 v[182:183], v15 offset:512
    ds_read_b64_tr_b16 v[184:185], v14 offset:4096
    ds_read_b64_tr_b16 v[186:187], v14 offset:4608
    ds_read_b64_tr_b16 v[188:189], v15 offset:4096
    ds_read_b64_tr_b16 v[190:191], v15 offset:4608
    s_waitcnt lgkmcnt(0)
    v_mfma_f32_32x32x16_bf16 v[160:175], v[32:35], v[176:179], 0
    ds_read_b64_tr_b16 v[192:193], v14 offset:8192
    ds_read_b64_tr_b16 v[194:195], v14 offset:8704
    ds_read_b64_tr_b16 v[196:197], v15 offset:8192
    ds_read_b64_tr_b16 v[198:199], v15 offset:8704
    v_mfma_f32_32x32x16_bf16 v[160:175], v[36:39], v[180:183], v[160:175]
    ds_read_b64_tr_b16 v[200:201], v14 offset:12288
    ds_read_b64_tr_b16 v[202:203], v14 offset:12800
    ds_read_b64_tr_b16 v[204:205], v15 offset:12288
    ds_read_b64_tr_b16 v[206:207], v15 offset:12800
    v_mfma_f32_32x32x16_bf16 v[160:175], v[40:43], v[184:187], v[160:175]
    v_subrev_u32 v9, 2048, v9
    s_add_u32 m0, s63, 65536
    s_nop 0
    buffer_load_dwordx4 v9, s[12:15], s52 offen  lds
    v_mfma_f32_32x32x16_bf16 v[160:175], v[44:47], v[188:191], v[160:175]
    s_add_u32 m0, s63, 73728
    s_nop 0
    buffer_load_dwordx4 v9, s[12:15], s53 offen  lds
    v_mfma_f32_16x16x32_bf16 v[20:23], v[28:31], v[176:179], 0
    s_mov_b32 s69, 0
    v_mfma_f32_16x16x32_bf16 v[20:23], v[28:31], v[184:187], v[20:23]
    v_readfirstlane_b32 s65, v17
    s_waitcnt vmcnt(7) lgkmcnt(0)
    s_barrier
    v_mfma_f32_32x32x16_bf16 v[160:175], v[48:51], v[192:195], v[160:175]
    ds_read_b64_tr_b16 v[176:177], v14 offset:16384
    ds_read_b64_tr_b16 v[178:179], v14 offset:16896
    ds_read_b64_tr_b16 v[180:181], v15 offset:16384
    ds_read_b64_tr_b16 v[182:183], v15 offset:16896
    v_mfma_f32_32x32x16_bf16 v[160:175], v[52:55], v[196:199], v[160:175]
    ds_read_b64_tr_b16 v[184:185], v14 offset:20480
    ds_read_b64_tr_b16 v[186:187], v14 offset:20992
    ds_read_b64_tr_b16 v[188:189], v15 offset:20480
    ds_read_b64_tr_b16 v[190:191], v15 offset:20992
    v_mfma_f32_32x32x16_bf16 v[160:175], v[56:59], v[200:203], v[160:175]
    s_add_u32 m0, s63, 81920
    s_nop 0
    buffer_load_dwordx4 v9, s[12:15], s54 offen  lds
    s_add_u32 m0, s63, 90112
    v_mfma_f32_32x32x16_bf16 v[160:175], v[60:63], v[204:207], v[160:175]
    buffer_load_dwordx4 v9, s[12:15], s55 offen  lds
    s_cmp_lg_u32 s65, 0
    s_cbranch_scc0 L_nonce_spinb
L_nonce_okb:
    s_lshl_b32 s79, s65, 1
    v_mfma_f32_16x16x32_bf16 v[20:23], v[28:31], v[192:195], v[20:23]
    s_mul_i32 s80, s67, s65
    v_mfma_f32_16x16x32_bf16 v[20:23], v[28:31], v[200:203], v[20:23]
    s_waitcnt lgkmcnt(0)
    v_mfma_f32_32x32x16_bf16 v[160:175], v[64:67], v[176:179], v[160:175]
    ds_read_b64_tr_b16 v[192:193], v14 offset:24576
    ds_read_b64_tr_b16 v[194:195], v14 offset:25088
    ds_read_b64_tr_b16 v[196:197], v15 offset:24576
    ds_read_b64_tr_b16 v[198:199], v15 offset:25088
    v_mfma_f32_32x32x16_bf16 v[160:175], v[68:71], v[180:183], v[160:175]
    ds_read_b64_tr_b16 v[200:201], v14 offset:28672
    ds_read_b64_tr_b16 v[202:203], v14 offset:29184
    ds_read_b64_tr_b16 v[204:205], v15 offset:28672
    ds_read_b64_tr_b16 v[206:207], v15 offset:29184
    v_mfma_f32_32x32x16_bf16 v[160:175], v[72:75], v[184:187], v[160:175]
    s_add_u32 m0, s63, 98304
    s_nop 0
    buffer_load_dwordx4 v9, s[12:15], s56 offen  lds
    s_add_u32 m0, s63, 106496
    v_mfma_f32_32x32x16_bf16 v[160:175], v[76:79], v[188:191], v[160:175]
    buffer_load_dwordx4 v9, s[12:15], s57 offen  lds
    v_mfma_f32_16x16x32_bf16 v[20:23], v[28:31], v[176:179], v[20:23]
    v_mfma_f32_16x16x32_bf16 v[20:23], v[28:31], v[184:187], v[20:23]
    s_waitcnt vmcnt(4) lgkmcnt(0)
    s_barrier
    v_mfma_f32_32x32x16_bf16 v[160:175], v[80:83], v[192:195], v[160:175]
    ds_read_b64_tr_b16 v[176:177], v14 offset:32768
    ds_read_b64_tr_b16 v[178:179], v14 offset:33280
    ds_read_b64_tr_b16 v[180:181], v15 offset:32768
    ds_read_b64_tr_b16 v[182:183], v15 offset:33280
    v_mfma_f32_32x32x16_bf16 v[160:175], v[84:87], v[196:199], v[160:175]
    ds_read_b64_tr_b16 v[184:185], v14 offset:36864
    ds_read_b64_tr_b16 v[186:187], v14 offset:37376
    ds_read_b64_tr_b16 v[188:189], v15 offset:36864
    ds_read_b64_tr_b16 v[190:191], v15 offset:37376
    v_mfma_f32_32x32x16_bf16 v[160:175], v[88:91], v[200:203], v[160:175]
    s_add_u32 m0, s63, 114688
    s_nop 0
    buffer_load_dwordx4 v9, s[12:15], s58 offen  lds
    s_add_u32 m0, s63, 122880
    v_mfma_f32_32x32x16_bf16 v[160:175], v[92:95], v[204:207], v[160:175]
    buffer_load_dwordx4 v9, s[12:15], s59 offen  lds
    v_mfma_f32_16x16x32_bf16 v[20:23], v[28:31], v[192:195], v[20:23]
    v_mfma_f32_16x16x32_bf16 v[20:23], v[28:31], v[200:203], v[20:23]
    s_waitcnt lgkmcnt(0)
    v_mfma_f32_32x32x16_bf16 v[160:175], v[96:99], v[176:179], v[160:175]
    ds_read_b64_tr_b16 v[192:193], v14 offset:40960
    ds_read_b64_tr_b16 v[194:195], v14 offset:41472
    ds_read_b64_tr_b16 v[196:197], v15 offset:40960
    ds_read_b64_tr_b16 v[198:199], v15 offset:41472
    v_mfma_f32_32x32x16_bf16 v[160:175], v[100:103], v[180:183], v[160:175]
    ds_read_b64_tr_b16 v[200:201], v14 offset:45056
    ds_read_b64_tr_b16 v[202:203], v14 offset:45568
    ds_read_b64_tr_b16 v[204:205], v15 offset:45056
    ds_read_b64_tr_b16 v[206:207], v15 offset:45568
    v_mfma_f32_32x32x16_bf16 v[160:175], v[104:107], v[184:187], v[160:175]
    v_mfma_f32_32x32x16_bf16 v[160:175], v[108:111], v[188:191], v[160:175]
    v_mfma_f32_16x16x32_bf16 v[20:23], v[28:31], v[176:179], v[20:23]
    v_mfma_f32_16x16x32_bf16 v[20:23], v[28:31], v[184:187], v[20:23]
    s_waitcnt vmcnt(4) lgkmcnt(0)
    s_barrier
    v_mfma_f32_32x32x16_bf16 v[160:175], v[112:115], v[192:195], v[160:175]
    ds_read_b64_tr_b16 v[176:177], v14 offset:49152
    ds_read_b64_tr_b16 v[178:179], v14 offset:49664
    ds_read_b64_tr_b16 v[180:181], v15 offset:49152
    ds_read_b64_tr_b16 v[182:183], v15 offset:49664
    v_mfma_f32_32x32x16_bf16 v[160:175], v[116:119], v[196:199], v[160:175]
    ds_read_b64_tr_b16 v[184:185], v14 offset:53248
    ds_read_b64_tr_b16 v[186:187], v14 offset:53760
    ds_read_b64_tr_b16 v[188:189], v15 offset:53248
    ds_read_b64_tr_b16 v[190:191], v15 offset:53760
    v_mfma_f32_32x32x16_bf16 v[160:175], v[120:123], v[200:203], v[160:175]
    v_mfma_f32_32x32x16_bf16 v[160:175], v[124:127], v[204:207], v[160:175]
    v_mfma_f32_16x16x32_bf16 v[20:23], v[28:31], v[192:195], v[20:23]
    v_mfma_f32_16x16x32_bf16 v[20:23], v[28:31], v[200:203], v[20:23]
    s_waitcnt lgkmcnt(0)
    v_mfma_f32_32x32x16_bf16 v[160:175], v[128:131], v[176:179], v[160:175]
    ds_read_b64_tr_b16 v[192:193], v14 offset:57344
    ds_read_b64_tr_b16 v[194:195], v14 offset:57856
    ds_read_b64_tr_b16 v[196:197], v15 offset:57344
    ds_read_b64_tr_b16 v[198:199], v15 offset:57856
    v_mfma_f32_32x32x16_bf16 v[160:175], v[132:135], v[180:183], v[160:175]
    ds_read_b64_tr_b16 v[200:201], v14 offset:61440
    ds_read_b64_tr_b16 v[202:203], v14 offset:61952
    ds_read_b64_tr_b16 v[204:205], v15 offset:61440
    ds_read_b64_tr_b16 v[206:207], v15 offset:61952
    v_mfma_f32_32x32x16_bf16 v[160:175], v[136:139], v[184:187], v[160:175]
    v_mfma_f32_32x32x16_bf16 v[160:175], v[140:143], v[188:191], v[160:175]
    v_mfma_f32_16x16x32_bf16 v[20:23], v[28:31], v[176:179], v[20:23]
    v_mfma_f32_16x16x32_bf16 v[20:23], v[28:31], v[184:187], v[20:23]
    s_waitcnt vmcnt(2) lgkmcnt(0)
    s_barrier
    v_mfma_f32_32x32x16_bf16 v[160:175], v[144:147], v[192:195], v[160:175]
    v_lshlrev_b32 v232, 2, v0
    v_add_u32 v232, 161280, v232
    ds_read_b32 v6, v232
    s_lshl_b32 s3, s84, 7
    v_mfma_f32_32x32x16_bf16 v[160:175], v[148:151], v[196:199], v[160:175]
    s_add_u32 s3, s3, 161536
    v_lshrrev_b32 v232, 5, v1
    v_lshl_add_u32 v232, v232, 4, s3
    ds_read_b128 v[208:211], v232 offset:0
    v_mfma_f32_32x32x16_bf16 v[160:175], v[152:155], v[200:203], v[160:175]
    ds_read_b128 v[212:215], v232 offset:32
    ds_read_b128 v[216:219], v232 offset:64
    ds_read_b128 v[220:223], v232 offset:96
    v_add_u32 v19, 2048, v19
    v_mfma_f32_32x32x16_bf16 v[160:175], v[156:159], v[204:207], v[160:175]
    v_bfe_u32 v232, v1, 4, 1
    v_mul_u32_u24 v232, 768, v232
    v_add_u32 v245, v232, v2
    v_mfma_f32_16x16x32_bf16 v[20:23], v[28:31], v[192:195], v[20:23]
    v_mfma_f32_16x16x32_bf16 v[20:23], v[28:31], v[200:203], v[20:23]
    s_nop 7
    v_cvt_pk_bf16_f32 v234, v20, v21
    v_lshlrev_b32 v22, 16, v234
    v_and_b32 v23, s76, v234
    v_sub_f32 v20, v20, v22
    v_sub_f32 v21, v21, v23
    v_cvt_pk_bf16_f32 v20, v22, v20
    v_cvt_pk_bf16_f32 v21, v23, v21
    s_mov_b64 exec, 0xffff
    ds_write2_b32 v19, v20, v21 offset0:0 offset1:32
    s_mov_b64 exec, -1
    s_waitcnt lgkmcnt(5)
    v_cvt_pk_bf16_f32 v24, -v6, -v6
    v_mov_b64 v[26:27], 0
    s_mov_b32 exec_lo, 0
    v_mov_b32 v24, 0
    s_mov_b32 exec_lo, -1
    v_mov_b32 v25, v24
    s_setprio 0
    s_waitcnt vmcnt(0) lgkmcnt(0)
    s_barrier
    ds_read_b64 v[240:241], v253 offset:2048
    v_mov_b64 v[242:243], 0
    s_waitcnt lgkmcnt(0)
    s_nop 0
    v_mfma_f32_32x32x16_bf16 v[160:175], v[24:27], v[240:243], v[160:175]
    v_mov_b64 v[36:37], s[90:91]
    v_mov_b64 v[38:39], s[90:91]
    v_mov_b64 v[44:45], s[90:91]
    v_mov_b64 v[46:47], s[90:91]
    v_mov_b64 v[52:53], s[90:91]
    v_mov_b64 v[54:55], s[90:91]
    v_mov_b64 v[60:61], s[90:91]
    v_mov_b64 v[62:63], s[90:91]
    v_mov_b64 v[68:69], s[90:91]
    v_mov_b64 v[70:71], s[90:91]
    s_nop 1
    v_mul_f32 v160, v208, v160
    v_mul_f32 v161, v209, v161
    v_mul_f32 v162, v210, v162
    v_mul_f32 v163, v211, v163
    v_mul_f32 v164, v212, v164
    v_mul_f32 v165, v213, v165
    v_mul_f32 v166, v214, v166
    v_mul_f32 v167, v215, v167
    v_mul_f32 v168, v216, v168
    v_mul_f32 v169, v217, v169
    v_mul_f32 v170, v218, v170
    v_mul_f32 v171, v219, v171
    v_mul_f32 v172, v220, v172
    v_mul_f32 v173, v221, v173
    v_mul_f32 v174, v222, v174
    v_mul_f32 v175, v223, v175
    v_cvt_pk_bf16_f32 v208, v160, v161
    v_cvt_pk_bf16_f32 v209, v162, v163
    v_cvt_pk_bf16_f32 v210, v164, v165
    v_cvt_pk_bf16_f32 v211, v166, v167
    v_cvt_pk_bf16_f32 v212, v168, v169
    v_cvt_pk_bf16_f32 v213, v170, v171
    v_cvt_pk_bf16_f32 v214, v172, v173
    v_cvt_pk_bf16_f32 v215, v174, v175
    s_add_u32 s3, s81, 2097152
    v_add_u32 v232, v208, v210
    v_add_u32 v234, v212, v214
    buffer_store_dwordx4 v[208:211], v245, s[16:19], s3 offen sc1
    buffer_store_dwordx4 v[212:215], v245, s[16:19], s3 offen offset:256 sc1
    v_add_u32_dpp v233, v232, v232 row_ror:8 row_mask:0xf bank_mask:0xf
    v_add_u32_dpp v235, v234, v234 row_ror:8 row_mask:0xf bank_mask:0xf
    s_nop 0
    v_add_u32_dpp v232, v233, v233 row_ror:4 row_mask:0xf bank_mask:0xf
    v_add_u32_dpp v234, v235, v235 row_ror:4 row_mask:0xf bank_mask:0xf
    s_nop 0
    v_add_u32_dpp v233, v232, v232 row_ror:2 row_mask:0xf bank_mask:0xf
    v_add_u32_dpp v235, v234, v234 row_ror:2 row_mask:0xf bank_mask:0xf
    s_nop 0
    v_add_u32_dpp v232, v233, v233 row_ror:1 row_mask:0xf bank_mask:0xf
    v_add_u32_dpp v234, v235, v235 row_ror:1 row_mask:0xf bank_mask:0xf
    s_nop 1
    v_mov_b32_dpp v232, v234 quad_perm:[0,1,2,3] row_mask:0xf bank_mask:0xc
    v_bfe_u32 v233, v1, 4, 1
    v_mad_u32_u24 v233, v233, 12, v4
    v_bfe_u32 v234, v1, 3, 1
    v_lshl_add_u32 v233, v234, 2, v233
    s_lshl_b32 s3, s70, 5
    v_sub_u32 v232, s65, v232
    buffer_store_dword v232, v233, s[16:19], s3 offen offset:128 sc1
    s_lshl1_add_u32 s3, s71, 32768
    v_add_u32 v232, s3, v245
    ds_write_b128 v232, v[208:211]
    ds_write_b128 v232, v[212:215] offset:256
    v_bfe_u32 v17, v1, 4, 2
    v_lshlrev_b32 v17, 5, v17
    v_xor_b32 v17, v17, v247
    buffer_load_dwordx4 v[208:211], v2, s[16:19], s48 offen
    buffer_load_dwordx4 v[212:215], v2, s[16:19], s49 offen
    buffer_load_dwordx4 v[216:219], v2, s[16:19], s50 offen
    buffer_load_dwordx4 v[220:223], v2, s[16:19], s51 offen
    buffer_load_dword v254, v244, s[16:19], 0 offen
    s_waitcnt lgkmcnt(0)
    s_barrier
    s_add_u32 s3, s63, 32768
    v_add_u32 v235, s3, v2
    v_add_u32 v234, 114688, v235
    ds_read_b128 v[176:179], v234
    ds_read_b128 v[32:35], v235
    v_mov_b32 v12, v235
    v_mov_b64 v[136:137], 0
    v_mov_b64 v[138:139], 0
    v_mov_b64 v[140:141], 0
    v_mov_b64 v[142:143], 0
    v_mov_b64 v[144:145], 0
    v_xor_b32 v234, 4096, v235
    s_mov_b32 s7, 6422528
    v_lshrrev_b32 v232, 1, v1
    v_and_b32 v233, 16, v2
    v_lshl_add_u32 v232, v232, 7, v233
    buffer_load_dwordx4 v[180:183], v232, s[16:19], s7 offen sc1
    s_setprio 1
    s_waitcnt lgkmcnt(0)
    v_permlane16_swap_b32 v32, v36
    v_permlane16_swap_b32 v33, v37
    v_permlane16_swap_b32 v34, v38
    v_permlane16_swap_b32 v35, v39
    s_waitcnt lgkmcnt(0)
    s_barrier
    ds_read_b128 v[168:171], v235 offset:8192
    ds_read_b128 v[172:175], v234 offset:8192
    s_waitcnt lgkmcnt(1)
    v_mfma_f32_32x32x16_bf16 v[72:87], v[176:179], v[168:171], 0
    s_nop 11
    v_exp_f32 v72, v72
    buffer_load_dwordx4 v[40:43], v246, s[16:19], s48 offen
    v_exp_f32 v73, v73
    v_exp_f32 v74, v74
    v_exp_f32 v75, v75
    buffer_load_dwordx4 v[48:51], v246, s[16:19], s49 offen
    v_exp_f32 v76, v76
    v_exp_f32 v77, v77
    v_exp_f32 v78, v78
    buffer_load_dwordx4 v[56:59], v246, s[16:19], s50 offen
    v_exp_f32 v79, v79
    v_exp_f32 v80, v80
    v_cvt_pk_bf16_f32 v152, v72, v73
    buffer_load_dwordx4 v[64:67], v246, s[16:19], s51 offen
    v_cvt_pk_bf16_f32 v153, v74, v75
    v_cvt_pk_bf16_f32 v154, v76, v77
    v_cvt_pk_bf16_f32 v155, v78, v79
    buffer_load_dword v255, v244, s[16:19], 0 offen offset:128
    v_and_b32 v152, v224, v152
    v_and_b32 v153, v225, v153
    v_and_b32 v154, v226, v154
    v_and_b32 v155, v227, v155
    v_exp_f32 v81, v81
    v_exp_f32 v82, v82
    v_mfma_f32_32x32x16_bf16 v[120:135], v[32:35], v[152:155], 0
    v_exp_f32 v83, v83
    v_exp_f32 v84, v84
    v_exp_f32 v85, v85
    v_exp_f32 v86, v86
    v_exp_f32 v87, v87
    v_cvt_pk_bf16_f32 v156, v80, v81
    v_cvt_pk_bf16_f32 v157, v82, v83
    v_cvt_pk_bf16_f32 v158, v84, v85
    v_cvt_pk_bf16_f32 v159, v86, v87
    v_and_b32 v156, v228, v156
    v_and_b32 v157, v229, v157
    v_and_b32 v158, v230, v158
    v_and_b32 v159, v231, v159
    s_nop 1
    v_mfma_f32_32x32x16_bf16 v[120:135], v[36:39], v[156:159], v[120:135]
    s_mov_b32 s69, 0
    s_waitcnt vmcnt(5)
L_cval0:
    v_cmp_ne_u32 vcc, s65, v183
    s_nop 0
    s_cbranch_vccnz L_cretry0
L_cok0:
    v_mov_b32 v232, v180
    s_nop 1
    v_max_u32_dpp v233, v232, v232 row_ror:8 row_mask:0xf bank_mask:0xf
    s_nop 1
    v_max_u32_dpp v232, v233, v233 row_ror:4 row_mask:0xf bank_mask:0xf
    s_nop 1
    v_max_u32_dpp v233, v232, v232 row_ror:2 row_mask:0xf bank_mask:0xf
    s_nop 1
    v_max_u32_dpp v232, v233, v233 row_ror:1 row_mask:0xf bank_mask:0xf
    s_nop 0
    v_readlane_b32 s3, v232, 0
    v_readlane_b32 s4, v232, 16
    v_readlane_b32 s5, v232, 32
    v_readlane_b32 s6, v232, 48
    s_max_u32 s3, s3, s4
    s_max_u32 s5, s5, s6
    s_max_u32 s73, s3, s5
    s_and_b32 s4, s73, 0x7ff
    s_sub_u32 s4, 2047, s4
    s_lshl3_add_u32 s5, s4, s86
    s_lshl_b32 s5, s5, 7
    v_and_b32 v232, 31, v1
    v_lshlrev_b32 v232, 2, v232
    buffer_load_dword v13, v232, s[8:11], s5 offen
    s_lshr_b32 s4, s4, 5
    v_readlane_b32 s98, v181, s4
    v_readlane_b32 s99, v182, s4
    v_mov_b32 v232, s73
    v_mov_b32 v233, 162304
    ds_write_b32 v233, v232
    s_branch L_afterB0
L_nonce_spina:
    buffer_load_dword v17, v3, s[20:23], 0 offen sc1
    s_waitcnt vmcnt(0)
    v_readfirstlane_b32 s65, v17
    s_nop 0
    s_cmp_lg_u32 s65, 0
    s_cbranch_scc1 L_nonce_oka
    s_add_u32 s69, s69, 1
    s_cmp_gt_u32 s69, 65536
    s_cbranch_scc0 L_nonce_spina
    s_branch L_nonce_oka
L_nonce_spinb:
    buffer_load_dword v17, v3, s[20:23], 0 offen sc1
    s_waitcnt vmcnt(0)
    v_readfirstlane_b32 s65, v17
    s_nop 0
    s_cmp_lg_u32 s65, 0
    s_cbranch_scc1 L_nonce_okb
    s_add_u32 s69, s69, 1
    s_cmp_gt_u32 s69, 65536
    s_cbranch_scc0 L_nonce_spinb
    s_branch L_nonce_okb
L_kretry:
    buffer_load_dwordx4 v[208:211], v2, s[16:19], s48 offen sc1
    buffer_load_dwordx4 v[212:215], v2, s[16:19], s49 offen sc1
    buffer_load_dwordx4 v[216:219], v2, s[16:19], s50 offen sc1
    buffer_load_dwordx4 v[220:223], v2, s[16:19], s51 offen sc1
    buffer_load_dword v254, v244, s[16:19], 0 offen sc1
    s_waitcnt vmcnt(0)
    s_add_u32 s69, s69, 1
    s_cmp_gt_u32 s69, 65536
    s_cbranch_scc0 L_kval
    s_branch L_kok
L_vretrye:
    buffer_load_dwordx4 v[40:43], v246, s[16:19], s48 offen sc1
    buffer_load_dwordx4 v[48:51], v246, s[16:19], s49 offen sc1
    buffer_load_dwordx4 v[56:59], v246, s[16:19], s50 offen sc1
    buffer_load_dwordx4 v[64:67], v246, s[16:19], s51 offen sc1
    buffer_load_dword v255, v244, s[16:19], 0 offen offset:128 sc1
    s_waitcnt vmcnt(0)
    s_add_u32 s69, s69, 1
    s_cmp_gt_u32 s69, 65536
    s_cbranch_scc0 L_vvale
    s_branch L_voke
L_g1b_x1:
    s_add_u32 m0, s63, 0
    s_add_u32 s82, s78, 0
    buffer_load_dwordx4 v17, s[28:31], s82 offen  lds
    s_add_u32 m0, s63, 8192
    s_add_u32 s82, s78, 65536
    buffer_load_dwordx4 v17, s[28:31], s82 offen  lds
    s_lshl_b32 s3, s70, 7
    s_add_u32 s3, s3, 161792
    v_and_b32 v232, 31, v1
    v_lshl_add_u32 v232, v232, 2, s3
    s_waitcnt vmcnt(2)
    v_lshlrev_b32 v236, 16, v13
    v_and_b32 v237, s76, v13
    v_subrev_f32 v236, s98, v236
    v_subrev_f32 v237, s98, v237
    v_cvt_pk_bf16_f32 v238, v236, v237
    v_lshlrev_b32 v236, 16, v238
    v_and_b32 v237, s76, v238
    v_mul_f32 v236, s99, v236
    v_mul_f32 v237, s99, v237
    v_cvt_pk_bf16_f32 v238, v236, v237
    ds_write_b32 v232, v238
    s_lshl_b32 s3, s70, 5
    s_add_u32 s3, s3, 131072
    v_xor_b32 v233, s3, v250
    ds_read_b64_tr_b16 v[104:105], v233 offset:0
    ds_read_b64_tr_b16 v[106:107], v233 offset:1024
    ds_read_b64_tr_b16 v[108:109], v233 offset:4096
    ds_read_b64_tr_b16 v[110:111], v233 offset:5120
    ds_read_b64_tr_b16 v[112:113], v233 offset:8192
    ds_read_b64_tr_b16 v[114:115], v233 offset:9216
    ds_read_b64_tr_b16 v[116:117], v233 offset:12288
    ds_read_b64_tr_b16 v[118:119], v233 offset:13312
    s_lshl_b32 s3, s70, 7
    s_add_u32 s3, s3, 161792
    v_lshrrev_b32 v232, 5, v1
    v_bfe_u32 v233, v1, 4, 1
    v_lshlrev_b32 v233, 3, v233
    v_lshl_add_u32 v232, v232, 5, v233
    v_add_u32 v232, s3, v232
    ds_read_b64 v[184:185], v232 offset:0
    ds_read_b64 v[186:187], v232 offset:16
    ds_read_b64 v[188:189], v232 offset:64
    ds_read_b64 v[190:191], v232 offset:80
    s_lshl3_add_u32 s3, s74, s86
    s_lshl2_add_u32 s3, s3, s70
    s_lshl_b32 s3, s3, 8
    s_add_u32 s3, s3, 6619136
    s_cmp_ge_u32 s74, 22
    s_cselect_b32 s3, 1073741824, s3
    s_waitcnt lgkmcnt(0)
    v_mfma_f32_16x16x32_bf16 v[192:195], v[184:187], v[104:107], 0
    v_mfma_f32_16x16x32_bf16 v[196:199], v[184:187], v[112:115], 0
    v_mfma_f32_16x16x32_bf16 v[192:195], v[188:191], v[108:111], v[192:195]
    v_mfma_f32_16x16x32_bf16 v[196:199], v[188:191], v[116:119], v[196:199]
    s_nop 6
    v_mov_b32 v193, s65
    v_mov_b32 v194, v196
    v_mov_b32 v195, s65
    s_mov_b64 exec, 0xffff
    buffer_store_dwordx4 v[192:195], v2, s[16:19], s3 offen sc1
    s_mov_b64 exec, -1
    s_add_u32 m0, s63, 16384
    s_add_u32 s82, s78, 131072
    buffer_load_dwordx4 v17, s[28:31], s82 offen  lds
    s_add_u32 m0, s63, 24576
    s_add_u32 s82, s78, 196608
    buffer_load_dwordx4 v17, s[28:31], s82 offen  lds
    s_add_u32 m0, s63, 65536
    s_add_u32 s82, s78, 262144
    buffer_load_dwordx4 v17, s[28:31], s82 offen  lds
    s_add_u32 m0, s63, 73728
    s_add_u32 s82, s78, 327680
    buffer_load_dwordx4 v17, s[28:31], s82 offen  lds
    s_add_u32 m0, s63, 81920
    s_add_u32 s82, s78, 393216
    buffer_load_dwordx4 v17, s[28:31], s82 offen  lds
    s_add_u32 m0, s63, 90112
    s_add_u32 s82, s78, 458752
    buffer_load_dwordx4 v17, s[28:31], s82 offen  lds
    buffer_load_dwordx4 v[8:11], v247, s[8:11], s77 offen
    s_nop 7
    v_mfma_f32_32x32x16_bf16 v[88:103], v[208:211], v[168:171], 0
    s_nop 11
    s_branch L_g1b_end
L_g1b_x2:
    v_mfma_f32_32x32x16_bf16 v[136:151], v[44:47], v[164:167], v[136:151]
    s_add_u32 m0, s63, 16384
    s_add_u32 s82, s78, 131072
    buffer_load_dwordx4 v17, s[28:31], s82 offen  lds
    s_add_u32 m0, s63, 24576
    s_add_u32 s82, s78, 196608
    buffer_load_dwordx4 v17, s[28:31], s82 offen  lds
    s_add_u32 m0, s63, 65536
    s_add_u32 s82, s78, 262144
    buffer_load_dwordx4 v17, s[28:31], s82 offen  lds
    s_add_u32 m0, s63, 73728
    s_add_u32 s82, s78, 327680
    buffer_load_dwordx4 v17, s[28:31], s82 offen  lds
    s_add_u32 m0, s63, 81920
    s_add_u32 s82, s78, 393216
    buffer_load_dwordx4 v17, s[28:31], s82 offen  lds
    s_add_u32 m0, s63, 90112
    s_add_u32 s82, s78, 458752
    buffer_load_dwordx4 v17, s[28:31], s82 offen  lds
    buffer_load_dwordx4 v[8:11], v247, s[8:11], s77 offen
    s_nop 7
    v_mfma_f32_32x32x16_bf16 v[88:103], v[208:211], v[168:171], 0
    s_nop 11
    s_branch L_g1b_end
L_g1b_x3:
    v_mfma_f32_32x32x16_bf16 v[136:151], v[52:55], v[156:159], v[136:151]
    s_add_u32 m0, s63, 81920
    s_add_u32 s82, s78, 393216
    buffer_load_dwordx4 v17, s[28:31], s82 offen  lds
    s_add_u32 m0, s63, 90112
    s_add_u32 s82, s78, 458752
    buffer_load_dwordx4 v17, s[28:31], s82 offen  lds
    buffer_load_dwordx4 v[8:11], v247, s[8:11], s77 offen
    s_nop 7
    v_mfma_f32_32x32x16_bf16 v[88:103], v[208:211], v[168:171], 0
    s_nop 11
    s_branch L_g1b_end
L_g1b_x4:
    v_mfma_f32_32x32x16_bf16 v[136:151], v[60:63], v[164:167], v[136:151]
    s_nop 7
    v_mfma_f32_32x32x16_bf16 v[88:103], v[208:211], v[168:171], 0
    s_nop 11
    s_branch L_g1b_end
L_g1a_x1:
    s_lshl2_add_u32 s3, s62, 162320
    v_mov_b32 v232, s65
    v_mov_b32 v233, s3
    s_waitcnt vmcnt(0)
    ds_write_b32 v233, v232
    s_nop 11
    s_branch L_g1a_end
L_g1a_x2:
    v_mfma_f32_32x32x16_bf16 v[120:135], v[44:47], v[164:167], v[120:135]
    s_lshl2_add_u32 s3, s62, 162320
    v_mov_b32 v232, s65
    v_mov_b32 v233, s3
    s_waitcnt vmcnt(0)
    ds_write_b32 v233, v232
    s_nop 11
    s_branch L_g1a_end
L_g1a_x3:
    v_mfma_f32_32x32x16_bf16 v[120:135], v[52:55], v[156:159], v[120:135]
    s_nop 11
    s_branch L_g1a_end
L_g1a_x4:
    v_mfma_f32_32x32x16_bf16 v[120:135], v[60:63], v[164:167], v[120:135]
    s_nop 11
    s_branch L_g1a_end
L_g0a_x1:
    s_add_u32 m0, s63, 0
    s_add_u32 s82, s78, 0
    buffer_load_dwordx4 v17, s[28:31], s82 offen  lds
    s_add_u32 m0, s63, 8192
    s_add_u32 s82, s78, 65536
    buffer_load_dwordx4 v17, s[28:31], s82 offen  lds
    s_add_u32 m0, s63, 16384
    s_add_u32 s82, s78, 131072
    buffer_load_dwordx4 v17, s[28:31], s82 offen  lds
    s_add_u32 m0, s63, 24576
    s_add_u32 s82, s78, 196608
    buffer_load_dwordx4 v17, s[28:31], s82 offen  lds
    s_add_u32 m0, s63, 65536
    s_add_u32 s82, s78, 262144
    buffer_load_dwordx4 v17, s[28:31], s82 offen  lds
    s_add_u32 m0, s63, 73728
    s_add_u32 s82, s78, 327680
    buffer_load_dwordx4 v17, s[28:31], s82 offen  lds
    s_add_u32 m0, s63, 81920
    s_add_u32 s82, s78, 393216
    buffer_load_dwordx4 v17, s[28:31], s82 offen  lds
    s_add_u32 m0, s63, 90112
    s_add_u32 s82, s78, 458752
    buffer_load_dwordx4 v17, s[28:31], s82 offen  lds
    buffer_load_dwordx4 v[8:11], v247, s[8:11], s77 offen
    s_lshl2_add_u32 s7, s74, s70
    s_lshl_b32 s7, s7, 14
    s_and_b32 s6, s2, 7
    s_lshl_b32 s6, s6, 7
    s_add_u32 s7, s7, s6
    buffer_load_dwordx4 v[192:195], v247, s[40:43], s7 offen nt
    s_add_u32 s7, s7, 8192
    buffer_load_dwordx4 v[196:199], v247, s[40:43], s7 offen nt
    s_lshl_b32 s87, s74, 13
    s_lshl_b32 s6, s70, 8
    s_add_u32 s87, s87, s6
    s_add_u32 s87, s87, 6619136
    v_and_b32 v232, 7, v1
    v_lshrrev_b32 v233, 3, v1
    v_lshlrev_b32 v233, 4, v233
    v_lshl_add_u32 v254, v232, 10, v233
    s_cmp_ge_u32 s74, 22
    s_cselect_b32 s87, 1073741824, s87
    buffer_load_dwordx4 v[200:203], v254, s[16:19], s87 offen offset:0 sc1
    buffer_load_dwordx4 v[204:207], v254, s[16:19], s87 offen offset:128 sc1
    s_nop 11
    s_branch L_g0a_end
L_g0a_x2:
    v_mfma_f32_32x32x16_bf16 v[120:135], v[44:47], v[156:159], v[120:135]
    s_add_u32 m0, s63, 65536
    s_add_u32 s82, s78, 262144
    buffer_load_dwordx4 v17, s[28:31], s82 offen  lds
    s_add_u32 m0, s63, 73728
    s_add_u32 s82, s78, 327680
    buffer_load_dwordx4 v17, s[28:31], s82 offen  lds
    s_add_u32 m0, s63, 81920
    s_add_u32 s82, s78, 393216
    buffer_load_dwordx4 v17, s[28:31], s82 offen  lds
    s_add_u32 m0, s63, 90112
    s_add_u32 s82, s78, 458752
    buffer_load_dwordx4 v17, s[28:31], s82 offen  lds
    buffer_load_dwordx4 v[8:11], v247, s[8:11], s77 offen
    s_lshl2_add_u32 s7, s74, s70
    s_lshl_b32 s7, s7, 14
    s_and_b32 s6, s2, 7
    s_lshl_b32 s6, s6, 7
    s_add_u32 s7, s7, s6
    buffer_load_dwordx4 v[192:195], v247, s[40:43], s7 offen nt
    s_add_u32 s7, s7, 8192
    buffer_load_dwordx4 v[196:199], v247, s[40:43], s7 offen nt
    s_lshl_b32 s87, s74, 13
    s_lshl_b32 s6, s70, 8
    s_add_u32 s87, s87, s6
    s_add_u32 s87, s87, 6619136
    v_and_b32 v232, 7, v1
    v_lshrrev_b32 v233, 3, v1
    v_lshlrev_b32 v233, 4, v233
    v_lshl_add_u32 v254, v232, 10, v233
    s_cmp_ge_u32 s74, 22
    s_cselect_b32 s87, 1073741824, s87
    buffer_load_dwordx4 v[200:203], v254, s[16:19], s87 offen offset:0 sc1
    buffer_load_dwordx4 v[204:207], v254, s[16:19], s87 offen offset:128 sc1
    s_nop 11
    s_branch L_g0a_end
L_g0a_x3:
    v_mfma_f32_32x32x16_bf16 v[120:135], v[52:55], v[164:167], v[120:135]
    buffer_load_dwordx4 v[8:11], v247, s[8:11], s77 offen
    s_lshl2_add_u32 s7, s74, s70
    s_lshl_b32 s7, s7, 14
    s_and_b32 s6, s2, 7
    s_lshl_b32 s6, s6, 7
    s_add_u32 s7, s7, s6
    buffer_load_dwordx4 v[192:195], v247, s[40:43], s7 offen nt
    s_add_u32 s7, s7, 8192
    buffer_load_dwordx4 v[196:199], v247, s[40:43], s7 offen nt
    s_lshl_b32 s87, s74, 13
    s_lshl_b32 s6, s70, 8
    s_add_u32 s87, s87, s6
    s_add_u32 s87, s87, 6619136
    v_and_b32 v232, 7, v1
    v_lshrrev_b32 v233, 3, v1
    v_lshlrev_b32 v233, 4, v233
    v_lshl_add_u32 v254, v232, 10, v233
    s_cmp_ge_u32 s74, 22
    s_cselect_b32 s87, 1073741824, s87
    buffer_load_dwordx4 v[200:203], v254, s[16:19], s87 offen offset:0 sc1
    buffer_load_dwordx4 v[204:207], v254, s[16:19], s87 offen offset:128 sc1
    s_nop 11
    s_branch L_g0a_end
L_g0a_x4:
    v_mfma_f32_32x32x16_bf16 v[120:135], v[60:63], v[156:159], v[120:135]
    s_lshl_b32 s87, s74, 13
    s_lshl_b32 s6, s70, 8
    s_add_u32 s87, s87, s6
    s_add_u32 s87, s87, 6619136
    v_and_b32 v232, 7, v1
    v_lshrrev_b32 v233, 3, v1
    v_lshlrev_b32 v233, 4, v233
    v_lshl_add_u32 v254, v232, 10, v233
    s_cmp_ge_u32 s74, 22
    s_cselect_b32 s87, 1073741824, s87
    buffer_load_dwordx4 v[200:203], v254, s[16:19], s87 offen offset:0 sc1
    buffer_load_dwordx4 v[204:207], v254, s[16:19], s87 offen offset:128 sc1
    s_nop 11
    s_branch L_g0a_end
L_g0b_x1:
    s_lshl2_add_u32 s3, s62, 162320
    v_mov_b32 v232, s65
    v_mov_b32 v233, s3
    s_waitcnt vmcnt(6)
    ds_write_b32 v233, v232
    s_nop 11
    s_branch L_g0b_end
L_g0b_x2:
    v_mfma_f32_32x32x16_bf16 v[136:151], v[44:47], v[156:159], v[136:151]
    s_nop 11
    s_branch L_g0b_end
L_g0b_x3:
    v_mfma_f32_32x32x16_bf16 v[136:151], v[52:55], v[164:167], v[136:151]
    s_nop 11
    s_branch L_g0b_end
L_cretry0:
    s_mov_b32 s7, 6422528
    v_lshrrev_b32 v232, 1, v1
    v_and_b32 v233, 16, v2
    v_lshl_add_u32 v232, v232, 7, v233
    buffer_load_dwordx4 v[180:183], v232, s[16:19], s7 offen sc1
    s_waitcnt vmcnt(0)
    s_add_u32 s69, s69, 1
    s_cmp_gt_u32 s69, 65536
    s_cbranch_scc0 L_cval0
    s_branch L_cok0
L_gretry:
    buffer_load_dwordx4 v[200:203], v254, s[16:19], s87 offen offset:0 sc1
    buffer_load_dwordx4 v[204:207], v254, s[16:19], s87 offen offset:128 sc1
    s_waitcnt vmcnt(0)
    s_add_u32 s69, s69, 1
    s_cmp_gt_u32 s69, 65536
    s_cbranch_scc0 L_gval
    s_branch L_gok
L_oretry:
    buffer_load_dword v15, v249, s[16:19], s83 offen sc1
    s_bitcmp0_b32 s75, 0
    s_cbranch_scc1 L_orel0
    s_or_b32 s3, s83, 0
    buffer_load_dwordx4 v[160:163], v248, s[16:19], s3 offen sc1
    buffer_load_dwordx4 v[164:167], v248, s[16:19], s3 offen offset:2048 sc1
L_orel0:
    s_bitcmp0_b32 s75, 1
    s_cbranch_scc1 L_orel1
    s_or_b32 s3, s83, 8192
    buffer_load_dwordx4 v[168:171], v248, s[16:19], s3 offen sc1
    buffer_load_dwordx4 v[172:175], v248, s[16:19], s3 offen offset:2048 sc1
L_orel1:
    s_bitcmp0_b32 s75, 2
    s_cbranch_scc1 L_orel2
    s_or_b32 s3, s83, 16384
    buffer_load_dwordx4 v[176:179], v248, s[16:19], s3 offen sc1
    buffer_load_dwordx4 v[180:183], v248, s[16:19], s3 offen offset:2048 sc1
L_orel2:
    s_bitcmp0_b32 s75, 3
    s_cbranch_scc1 L_orel3
    s_or_b32 s3, s83, 24576
    buffer_load_dwordx4 v[184:187], v248, s[16:19], s3 offen sc1
    buffer_load_dwordx4 v[188:191], v248, s[16:19], s3 offen offset:2048 sc1
L_orel3:
    s_waitcnt vmcnt(0)
    s_bitcmp0_b32 s75, 0
    s_cbranch_scc1 L_onext0
    v_add3_u32 v232, v160, v162, v164
    v_add_u32 v232, v232, v166
    s_nop 1
    v_add_u32_dpp v232, v15, v232 quad_perm:[0,1,2,3] row_mask:0xf bank_mask:1
    s_nop 1
    v_add_u32_dpp v233, v232, v232 row_ror:8 row_mask:0xf bank_mask:0xf
    s_nop 1
    v_add_u32_dpp v232, v233, v233 row_ror:4 row_mask:0xf bank_mask:0xf
    s_nop 1
    v_add_u32_dpp v233, v232, v232 row_ror:2 row_mask:0xf bank_mask:0xf
    s_nop 1
    v_add_u32_dpp v232, v233, v233 row_ror:1 row_mask:0xf bank_mask:0xf
    v_cmp_ne_u32 vcc, s79, v232
    s_nop 0
    s_cbranch_vccnz L_onext0
    v_mfma_f32_16x16x32_bf16 v[192:195], v[32:35], v[160:163], v[192:195]
    v_mfma_f32_16x16x32_bf16 v[196:199], v[36:39], v[160:163], v[196:199]
    v_mfma_f32_16x16x32_bf16 v[200:203], v[40:43], v[160:163], v[200:203]
    v_mfma_f32_16x16x32_bf16 v[204:207], v[44:47], v[160:163], v[204:207]
    v_mfma_f32_16x16x32_bf16 v[192:195], v[48:51], v[164:167], v[192:195]
    v_mfma_f32_16x16x32_bf16 v[196:199], v[52:55], v[164:167], v[196:199]
    v_mfma_f32_16x16x32_bf16 v[200:203], v[56:59], v[164:167], v[200:203]
    v_mfma_f32_16x16x32_bf16 v[204:207], v[60:63], v[164:167], v[204:207]
    s_bitset0_b32 s75, 0
L_onext0:
    s_bitcmp0_b32 s75, 1
    s_cbranch_scc1 L_onext1
    v_add3_u32 v232, v168, v170, v172
    v_add_u32 v232, v232, v174
    s_nop 1
    v_add_u32_dpp v232, v15, v232 quad_perm:[0,1,2,3] row_mask:0xf bank_mask:2
    s_nop 1
    v_add_u32_dpp v233, v232, v232 row_ror:8 row_mask:0xf bank_mask:0xf
    s_nop 1
    v_add_u32_dpp v232, v233, v233 row_ror:4 row_mask:0xf bank_mask:0xf
    s_nop 1
    v_add_u32_dpp v233, v232, v232 row_ror:2 row_mask:0xf bank_mask:0xf
    s_nop 1
    v_add_u32_dpp v232, v233, v233 row_ror:1 row_mask:0xf bank_mask:0xf
    v_cmp_ne_u32 vcc, s79, v232
    s_nop 0
    s_cbranch_vccnz L_onext1
    v_mfma_f32_16x16x32_bf16 v[192:195], v[64:67], v[168:171], v[192:195]
    v_mfma_f32_16x16x32_bf16 v[196:199], v[68:71], v[168:171], v[196:199]
    v_mfma_f32_16x16x32_bf16 v[200:203], v[72:75], v[168:171], v[200:203]
    v_mfma_f32_16x16x32_bf16 v[204:207], v[76:79], v[168:171], v[204:207]
    v_mfma_f32_16x16x32_bf16 v[192:195], v[80:83], v[172:175], v[192:195]
    v_mfma_f32_16x16x32_bf16 v[196:199], v[84:87], v[172:175], v[196:199]
    v_mfma_f32_16x16x32_bf16 v[200:203], v[88:91], v[172:175], v[200:203]
    v_mfma_f32_16x16x32_bf16 v[204:207], v[92:95], v[172:175], v[204:207]
    s_bitset0_b32 s75, 1
L_onext1:
    s_bitcmp0_b32 s75, 2
    s_cbranch_scc1 L_onext2
    v_add3_u32 v232, v176, v178, v180
    v_add_u32 v232, v232, v182
    s_nop 1
    v_add_u32_dpp v232, v15, v232 quad_perm:[0,1,2,3] row_mask:0xf bank_mask:4
    s_nop 1
    v_add_u32_dpp v233, v232, v232 row_ror:8 row_mask:0xf bank_mask:0xf
    s_nop 1
    v_add_u32_dpp v232, v233, v233 row_ror:4 row_mask:0xf bank_mask:0xf
    s_nop 1
    v_add_u32_dpp v233, v232, v232 row_ror:2 row_mask:0xf bank_mask:0xf
    s_nop 1
    v_add_u32_dpp v232, v233, v233 row_ror:1 row_mask:0xf bank_mask:0xf
    v_cmp_ne_u32 vcc, s79, v232
    s_nop 0
    s_cbranch_vccnz L_onext2
    v_mfma_f32_16x16x32_bf16 v[192:195], v[96:99], v[176:179], v[192:195]
    v_mfma_f32_16x16x32_bf16 v[196:199], v[100:103], v[176:179], v[196:199]
    v_mfma_f32_16x16x32_bf16 v[200:203], v[104:107], v[176:179], v[200:203]
    v_mfma_f32_16x16x32_bf16 v[204:207], v[108:111], v[176:179], v[204:207]
    v_mfma_f32_16x16x32_bf16 v[192:195], v[112:115], v[180:183], v[192:195]
    v_mfma_f32_16x16x32_bf16 v[196:199], v[116:119], v[180:183], v[196:199]
    v_mfma_f32_16x16x32_bf16 v[200:203], v[120:123], v[180:183], v[200:203]
    v_mfma_f32_16x16x32_bf16 v[204:207], v[124:127], v[180:183], v[204:207]
    s_bitset0_b32 s75, 2
L_onext2:
    s_bitcmp0_b32 s75, 3
    s_cbranch_scc1 L_onext3
    v_add3_u32 v232, v184, v186, v188
    v_add_u32 v232, v232, v190
    s_nop 1
    v_add_u32_dpp v232, v15, v232 quad_perm:[0,1,2,3] row_mask:0xf bank_mask:8
    s_nop 1
    v_add_u32_dpp v233, v232, v232 row_ror:8 row_mask:0xf bank_mask:0xf
    s_nop 1
    v_add_u32_dpp v232, v233, v233 row_ror:4 row_mask:0xf bank_mask:0xf
    s_nop 1
    v_add_u32_dpp v233, v232, v232 row_ror:2 row_mask:0xf bank_mask:0xf
    s_nop 1
    v_add_u32_dpp v232, v233, v233 row_ror:1 row_mask:0xf bank_mask:0xf
    v_cmp_ne_u32 vcc, s79, v232
    s_nop 0
    s_cbranch_vccnz L_onext3
    v_mfma_f32_16x16x32_bf16 v[192:195], v[128:131], v[184:187], v[192:195]
    v_mfma_f32_16x16x32_bf16 v[196:199], v[132:135], v[184:187], v[196:199]
    v_mfma_f32_16x16x32_bf16 v[200:203], v[136:139], v[184:187], v[200:203]
    v_mfma_f32_16x16x32_bf16 v[204:207], v[140:143], v[184:187], v[204:207]
    v_mfma_f32_16x16x32_bf16 v[192:195], v[144:147], v[188:191], v[192:195]
    v_mfma_f32_16x16x32_bf16 v[196:199], v[148:151], v[188:191], v[196:199]
    v_mfma_f32_16x16x32_bf16 v[200:203], v[152:155], v[188:191], v[200:203]
    v_mfma_f32_16x16x32_bf16 v[204:207], v[156:159], v[188:191], v[204:207]
    s_bitset0_b32 s75, 3
L_onext3:
    s_cmp_eq_u32 s75, 0
    s_nop 7
    s_cbranch_scc1 L_odone
    s_add_u32 s69, s69, 1
    s_cmp_gt_u32 s69, 65536
    s_cbranch_scc0 L_oretry
    s_branch L_odone
L_ybad:
    s_cmp_eq_u32 s75, 2
    s_cselect_b32 s75, 2, 1
    s_cbranch_scc0 L_noyld
    s_add_u32 s69, s69, 1
    s_cmp_gt_u32 s69, 65536
    s_cbranch_scc0 L_yretry
    v_mov_b32 v65, s65
    s_branch L_yok
L_owner:
    s_mov_b32 s69, 0
    v_and_b32 v232, 7, v1
    v_lshlrev_b32 v232, 5, v232
    v_add_u32 v232, 156672, v232
    v_lshrrev_b32 v233, 3, v1
    s_and_b32 s3, s72, 7
    v_cmp_eq_u32 s[98:99], s3, v233
L_ospin:
    ds_read_b32 v234, v232 offset:256
    ds_read_b128 v[64:67], v232
    ds_read_b128 v[68:71], v232 offset:16
    s_waitcnt lgkmcnt(0)
    v_cmp_ne_u32 vcc, s65, v234
    s_nop 0
    s_cbranch_vccz L_ookk
    s_sleep 2
    s_add_u32 s69, s69, 1
    s_cmp_gt_u32 s69, 1048576
    s_cbranch_scc0 L_ospin
L_ookk:
    s_mov_b64 exec, s[98:99]
    v_pk_add_f32 v[16:17], v[16:17], v[64:65]
    v_pk_add_f32 v[18:19], v[18:19], v[66:67]
    v_pk_add_f32 v[20:21], v[20:21], v[68:69]
    v_pk_add_f32 v[22:23], v[22:23], v[70:71]
    s_mov_b64 exec, -1
    v_cvt_pk_bf16_f32 v32, v16, v17
    v_cvt_pk_bf16_f32 v33, v18, v19
    v_cvt_pk_bf16_f32 v34, v20, v21
    v_cvt_pk_bf16_f32 v35, v22, v23
    buffer_store_dwordx4 v[32:35], v247, s[44:47], s77 offen sc1
    s_branch L_owner_ret
L_fallback:
    s_waitcnt vmcnt(0)
    s_mov_b32 s69, 0
    v_and_b32 v232, 3, v1
    v_lshlrev_b32 v232, 2, v232
    v_add_u32 v232, 162336, v232
L_fspinf:
    ds_read_b32 v233, v232
    s_waitcnt lgkmcnt(0)
    v_cmp_ne_u32 vcc, s65, v233
    s_nop 0
    s_cbranch_vccz L_fokf
    s_sleep 1
    s_add_u32 s69, s69, 1
    s_cmp_gt_u32 s69, 65536
    s_cbranch_scc0 L_fspinf
L_fokf:
    v_and_b32 v232, 31, v1
    v_lshrrev_b32 v233, 5, v1
    v_lshlrev_b32 v233, 2, v233
    v_sub_u32 v232, v233, v232
    v_add_u32 v88, -1, v232
    v_ashrrev_i32 v88, 31, v88
    v_add_u32 v89, 0, v232
    v_ashrrev_i32 v89, 31, v89
    v_add_u32 v90, 1, v232
    v_ashrrev_i32 v90, 31, v90
    v_add_u32 v91, 2, v232
    v_ashrrev_i32 v91, 31, v91
    v_add_u32 v92, 7, v232
    v_ashrrev_i32 v92, 31, v92
    v_add_u32 v93, 8, v232
    v_ashrrev_i32 v93, 31, v93
    v_add_u32 v94, 9, v232
    v_ashrrev_i32 v94, 31, v94
    v_add_u32 v95, 10, v232
    v_ashrrev_i32 v95, 31, v95
    v_add_u32 v96, 15, v232
    v_ashrrev_i32 v96, 31, v96
    v_add_u32 v97, 16, v232
    v_ashrrev_i32 v97, 31, v97
    v_add_u32 v98, 17, v232
    v_ashrrev_i32 v98, 31, v98
    v_add_u32 v99, 18, v232
    v_ashrrev_i32 v99, 31, v99
    v_add_u32 v100, 23, v232
    v_ashrrev_i32 v100, 31, v100
    v_add_u32 v101, 24, v232
    v_ashrrev_i32 v101, 31, v101
    v_add_u32 v102, 25, v232
    v_ashrrev_i32 v102, 31, v102
    v_add_u32 v103, 26, v232
    v_ashrrev_i32 v103, 31, v103
    v_mov_b32 v238, 0xff800000
    v_mov_b32 v239, 0xff800000
    v_mov_b64 v[120:121], 0
    v_mov_b64 v[122:123], 0
    v_mov_b64 v[124:125], 0
    v_mov_b64 v[126:127], 0
    v_mov_b64 v[128:129], 0
    v_mov_b64 v[130:131], 0
    v_mov_b64 v[132:133], 0
    v_mov_b64 v[134:135], 0
    s_mov_b32 s49, 0
L_fb_pass:
    s_mov_b32 s48, 0
L_fb_tile:
    s_lshl1_add_u32 s3, s60, s68
    s_sub_u32 s3, s3, s48
    s_cbranch_scc1 L_fb_endpass
    s_lshr_b32 s4, s3, 1
    s_lshl3_add_u32 s4, s4, s61
    s_lshl_b32 s4, s4, 13
    s_and_b32 s3, s3, 1
    s_lshl_b32 s3, s3, 12
    s_add_u32 s4, s4, s3
    s_add_u32 s4, s4, s71
    buffer_load_dwordx4 v[176:179], v2, s[16:19], s4 offen sc1
    buffer_load_dwordx4 v[32:35], v246, s[16:19], s4 offen sc1
    v_mov_b64 v[36:37], s[90:91]
    v_mov_b64 v[38:39], s[90:91]
    s_cmp_eq_u32 s48, 8
    s_cselect_b32 s50, -1, 0
    s_and_b32 s3, s48, 7
    s_cselect_b32 s51, -1, 0
    s_waitcnt vmcnt(0)
    v_mfma_f32_32x32x16_bf16 v[72:87], v[176:179], v[168:171], 0
    v_permlane16_swap_b32 v32, v36
    v_permlane16_swap_b32 v33, v37
    v_permlane16_swap_b32 v34, v38
    v_permlane16_swap_b32 v35, v39
    v_xor_b32 v232, s50, v88
    v_or_b32 v232, s51, v232
    s_nop 5
    v_bfi_b32 v72, v232, v72, v239
    v_xor_b32 v232, s50, v89
    v_or_b32 v232, s51, v232
    v_bfi_b32 v73, v232, v73, v239
    v_xor_b32 v232, s50, v90
    v_or_b32 v232, s51, v232
    v_bfi_b32 v74, v232, v74, v239
    v_xor_b32 v232, s50, v91
    v_or_b32 v232, s51, v232
    v_bfi_b32 v75, v232, v75, v239
    v_xor_b32 v232, s50, v92
    v_or_b32 v232, s51, v232
    v_bfi_b32 v76, v232, v76, v239
    v_xor_b32 v232, s50, v93
    v_or_b32 v232, s51, v232
    v_bfi_b32 v77, v232, v77, v239
    v_xor_b32 v232, s50, v94
    v_or_b32 v232, s51, v232
    v_bfi_b32 v78, v232, v78, v239
    v_xor_b32 v232, s50, v95
    v_or_b32 v232, s51, v232
    v_bfi_b32 v79, v232, v79, v239
    v_xor_b32 v232, s50, v96
    v_or_b32 v232, s51, v232
    v_bfi_b32 v80, v232, v80, v239
    v_xor_b32 v232, s50, v97
    v_or_b32 v232, s51, v232
    v_bfi_b32 v81, v232, v81, v239
    v_xor_b32 v232, s50, v98
    v_or_b32 v232, s51, v232
    v_bfi_b32 v82, v232, v82, v239
    v_xor_b32 v232, s50, v99
    v_or_b32 v232, s51, v232
    v_bfi_b32 v83, v232, v83, v239
    v_xor_b32 v232, s50, v100
    v_or_b32 v232, s51, v232
    v_bfi_b32 v84, v232, v84, v239
    v_xor_b32 v232, s50, v101
    v_or_b32 v232, s51, v232
    v_bfi_b32 v85, v232, v85, v239
    v_xor_b32 v232, s50, v102
    v_or_b32 v232, s51, v232
    v_bfi_b32 v86, v232, v86, v239
    v_xor_b32 v232, s50, v103
    v_or_b32 v232, s51, v232
    v_bfi_b32 v87, v232, v87, v239
    s_cmp_lg_u32 s49, 0
    s_cbranch_scc1 L_fb_p2
    v_max_f32 v238, v238, v72
    v_max_f32 v238, v238, v73
    v_max_f32 v238, v238, v74
    v_max_f32 v238, v238, v75
    v_max_f32 v238, v238, v76
    v_max_f32 v238, v238, v77
    v_max_f32 v238, v238, v78
    v_max_f32 v238, v238, v79
    v_max_f32 v238, v238, v80
    v_max_f32 v238, v238, v81
    v_max_f32 v238, v238, v82
    v_max_f32 v238, v238, v83
    v_max_f32 v238, v238, v84
    v_max_f32 v238, v238, v85
    v_max_f32 v238, v238, v86
    v_max_f32 v238, v238, v87
    s_branch L_fb_next
L_fb_p2:
    v_sub_f32 v72, v72, v238
    v_sub_f32 v73, v73, v238
    v_sub_f32 v74, v74, v238
    v_sub_f32 v75, v75, v238
    v_sub_f32 v76, v76, v238
    v_sub_f32 v77, v77, v238
    v_sub_f32 v78, v78, v238
    v_sub_f32 v79, v79, v238
    v_sub_f32 v80, v80, v238
    v_sub_f32 v81, v81, v238
    v_sub_f32 v82, v82, v238
    v_sub_f32 v83, v83, v238
    v_sub_f32 v84, v84, v238
    v_sub_f32 v85, v85, v238
    v_sub_f32 v86, v86, v238
    v_sub_f32 v87, v87, v238
    v_exp_f32 v72, v72
    v_exp_f32 v73, v73
    v_exp_f32 v74, v74
    v_exp_f32 v75, v75
    v_exp_f32 v76, v76
    v_exp_f32 v77, v77
    v_exp_f32 v78, v78
    v_exp_f32 v79, v79
    v_exp_f32 v80, v80
    v_cvt_pk_bf16_f32 v152, v72, v73
    v_cvt_pk_bf16_f32 v153, v74, v75
    v_cvt_pk_bf16_f32 v154, v76, v77
    v_cvt_pk_bf16_f32 v155, v78, v79
    v_exp_f32 v81, v81
    v_exp_f32 v82, v82
    v_mfma_f32_32x32x16_bf16 v[120:135], v[32:35], v[152:155], v[120:135]
    v_exp_f32 v83, v83
    v_exp_f32 v84, v84
    v_exp_f32 v85, v85
    v_exp_f32 v86, v86
    v_exp_f32 v87, v87
    v_cvt_pk_bf16_f32 v156, v80, v81
    v_cvt_pk_bf16_f32 v157, v82, v83
    v_cvt_pk_bf16_f32 v158, v84, v85
    v_cvt_pk_bf16_f32 v159, v86, v87
    s_nop 1
    v_mfma_f32_32x32x16_bf16 v[120:135], v[36:39], v[156:159], v[120:135]
    s_nop 15
L_fb_next:
    s_add_u32 s48, s48, 1
    s_cmp_le_u32 s48, 8
    s_cbranch_scc1 L_fb_tile
L_fb_endpass:
    v_mov_b32 v232, v238
    s_nop 1
    v_permlane32_swap_b32 v232, v238
    v_max_f32 v238, v238, v232
    s_add_u32 s49, s49, 1
    s_cmp_lt_u32 s49, 2
    s_cbranch_scc1 L_fb_pass
    s_nop 15
    s_cmp_eq_u32 s68, 0
    s_cbranch_scc1 L_fb_reta
    s_branch L_fb_retb
L_code_end:
.section .rodata,"a"
.p2align 6
.amdhsa_kernel parallel_sum__sliding_block__moe_arch_mod__prompt_kernel
  .amdhsa_next_free_vgpr 256
  .amdhsa_next_free_sgpr 102
  .amdhsa_accum_offset 256
  .amdhsa_group_segment_fixed_size 0
  .amdhsa_kernarg_size 88
  .amdhsa_user_sgpr_count 2
  .amdhsa_user_sgpr_kernarg_segment_ptr 1
  .amdhsa_system_sgpr_workgroup_id_x 1
.end_amdhsa_kernel
```
